```python
import torch

def _softmax(x, axis=-1):
    return torch.softmax(x, dim=axis)
def _gelu(x):
    return torch.nn.functional.gelu(x, approximate="tanh")
def _silu(x):
    return torch.nn.functional.silu(x)
def _sigmoid(x):
    return torch.sigmoid(x)
def _layernorm(x, axis=-1, eps=1e-5):
    m = x.mean(dim=axis, keepdim=True)
    v = x.var(dim=axis, keepdim=True, unbiased=False)
    return (x - m) / torch.sqrt(v + eps)
def _scatter_add(tgt, idx, src, axis=0):
    return tgt.clone().index_add_(axis, idx, src)
def _segment_sum(src, seg, n):
    out = torch.zeros((n,) + src.shape[1:], dtype=src.dtype)
    return out.index_add_(0, seg, src)
def _pad(x, pw):
    flat = tuple(v for pair in reversed(pw) for v in pair)
    return torch.nn.functional.pad(x, flat)

kernel_name = 'interleave_layers__ssm_conv_h3__softmax_full_mha__prompt'

def setup_inputs():

    _w = (lambda a: (lambda t: t.to(torch.bfloat16) if t.is_floating_point() else t)(torch.as_tensor(a)))
    def _A_setup():
        B, S, D = 1, 2048, 576
        ks = 4
        return {
            "q": _w((lambda *s: torch.randn(*s, dtype=torch.bfloat16) * 0.05)(B, S, D)),
            "k": _w((lambda *s: torch.randn(*s, dtype=torch.bfloat16) * 0.4)(B, S, D)),
            "v": _w((lambda *s: torch.randn(*s, dtype=torch.bfloat16) * 0.4)(B, S, D)),
            "shift_k": _w((lambda *s: torch.randn(*s, dtype=torch.bfloat16) * 0.4)(D, ks) * 0.5),
            "ssm_k": _w((lambda *s: torch.randn(*s, dtype=torch.bfloat16) * 0.4)(D, S) * (1.0 / S ** 0.5)),
            "ssm_D": _w((lambda *s: torch.randn(*s, dtype=torch.bfloat16) * 0.4)(D)),
        }
    _A_in = _A_setup()

    def _B_setup():
        B, S, D = 1, 2048, 576
        return {
            "x": _w((lambda *s: torch.randn(*s, dtype=torch.bfloat16) * 0.05)(B, S, D)),
            "wqkv": _w((lambda *s: torch.randn(*s, dtype=torch.bfloat16) * 0.05)(D, 3 * D)),
            "wo": _w((lambda *s: torch.randn(*s, dtype=torch.bfloat16) * 0.05)(D, D)),
        }
    _B_in = _B_setup()

    return {
        "A_q": _A_in["q"],
        "A_k": _A_in["k"],
        "A_v": _A_in["v"],
        "A_shift_k": _A_in["shift_k"],
        "A_ssm_k": _A_in["ssm_k"],
        "A_ssm_D": _A_in["ssm_D"],
        "B_x": _B_in["x"],
        "B_wqkv": _B_in["wqkv"],
        "B_wo": _B_in["wo"],
    }

def reference(A_q, A_k, A_v, A_shift_k, A_ssm_k, A_ssm_D, B_x, B_wqkv, B_wo):
    def _A_ref(q, k, v, shift_k, ssm_k, ssm_D):
        B, S, D = q.shape
        ks = shift_k.shape[-1]
        k_pad = _pad(k, ((0, 0), (ks - 1, 0), (0, 0)))
        k_shift = torch.zeros_like(k)
        for t in range(ks):
            k_shift = k_shift + k_pad[:, t:t + S, :] * shift_k[:, ks - 1 - t][None, None, :]
        kv = k_shift * v
        L = 2 * S
        kv_pad = _pad(kv, ((0, 0), (0, S), (0, 0)))
        kf_pad = _pad(ssm_k, ((0, 0), (0, S)))
        kv_f = (lambda x, axes=(-2,-1): torch.fft.rfft2(x.float(), dim=axes))(kv_pad[:, None, :, :], axes=(1, 2))
        kf_f = (lambda x, axes=(-2,-1): torch.fft.rfft2(x.float(), dim=axes))(kf_pad[:, None, :], axes=(1, 2))
        kf_f = (lambda x, *d: x.permute(*d))(kf_f, 1, 2, 0)
        y_f = kv_f * kf_f[None, :, :, :]
        y = (lambda x, s, axes=(-2,-1): torch.fft.irfft2(x, s=s, dim=axes).to(torch.bfloat16))(y_f, (1, L), axes=(1, 2))[:, 0, :S, :]
        y = y + kv * ssm_D[None, None, :]
        return q * y

    def _B_ref(x, wqkv, wo):
        B, S, D = x.shape
        H = 32; Dh = D // H
        qkv = (lambda x, *d: x.permute(*d))((x @ wqkv).reshape(B, S, 3, H, Dh), 2, 0, 3, 1, 4)
        q, k, v = qkv[0], qkv[1], qkv[2]
        scale = Dh ** -0.5
        scores = torch.einsum("bhqd,bhkd->bhqk", q, k) * scale
        p = _softmax(scores, axis=-1)
        o = torch.einsum("bhqk,bhkd->bhqd", p, v)
        return (lambda x, *d: x.permute(*d))(o, 0, 2, 1, 3).reshape(B, S, D) @ wo

    x = A_q
    x = x + _A_ref(_layernorm(x, axis=-1), A_k, A_v, A_shift_k, A_ssm_k, A_ssm_D)
    x = x + _B_ref(_layernorm(x, axis=-1), B_wqkv, B_wo)
    x = x + _A_ref(_layernorm(x, axis=-1), A_k, A_v, A_shift_k, A_ssm_k, A_ssm_D)
    x = x + _B_ref(_layernorm(x, axis=-1), B_wqkv, B_wo)
    return x
```

```asm
; @launch grid=(256,1,1) block=(512,1,1) lds=163840
.amdgcn_target "amdgcn-amd-amdhsa--gfx950"
.text
.p2align 12
.globl interleave_layers__ssm_conv_h3__softmax_full_mha__prompt_kernel
.p2align 8
.type interleave_layers__ssm_conv_h3__softmax_full_mha__prompt_kernel,@function
interleave_layers__ssm_conv_h3__softmax_full_mha__prompt_kernel:
    s_cmp_ge_u32 s2, 256
    s_cbranch_scc1 L_exit
    s_load_dwordx16 s[32:47], s[0:1], 0
    s_load_dwordx8 s[48:55], s[0:1], 64
    s_getpc_b64 s[16:17]
L_pc_here:
    s_and_b32 s17, s17, 0xffff
    s_mov_b32 s18, (L_code_end-L_pc_here)
    s_mov_b32 s19, 0x20000
    s_lshr_b32 s3, s2, 3
    s_mul_i32 s3, s3, 1280
    v_lshlrev_b32 v1, 6, v0
    v_cmp_gt_u32 vcc, 20, v0
    v_bfrev_b32 v2, -2
    s_nop 0
    v_cndmask_b32 v1, v2, v1, vcc
    buffer_load_dword v254, v1, s[16:19], s3 offen
    v_lshrrev_b32 v1, 6, v0
    v_and_b32 v2, 63, v0
    s_and_b32 s24, s2, 7
    v_readfirstlane_b32 s26, v1
    s_lshr_b32 s25, s2, 3
    s_mov_b32 s27, 0
    s_add_u32 s30, s26, s25
    s_and_b32 s31, s30, 3
    s_and_b32 s30, s30, 7
    s_waitcnt lgkmcnt(0)
    s_mov_b32 s4, s54
    s_mov_b32 s5, s55
    s_mov_b32 s6, 37748736
    s_mov_b32 s7, 0x20000
    v_mov_b32 v248, 0
    s_load_dwordx2 s[28:29], s[54:55], 0
    s_mov_b32 s8, s34
    s_mov_b32 s9, s35
    s_mov_b32 s10, 2359296
    s_mov_b32 s11, 0x20000
    s_mov_b32 s12, s36
    s_mov_b32 s13, s37
    s_mov_b32 s14, 2359296
    s_mov_b32 s15, 0x20000
    s_mov_b32 s64, 0x1c71c71d
    s_and_b32 s84, s25, 7
    s_lshr_b32 s85, s25, 3
    s_lshl_b32 s60, s24, 2
    s_add_u32 s85, s85, s60
    s_mul_i32 s60, s85, 73728
    s_mul_i32 s61, s84, 144
    s_add_u32 s60, s60, s61
    s_sub_u32 s61, s60, 4608
    v_mul_hi_u32 v3, v0, s64
    v_mul_u32_u24 v4, 9, v3
    v_sub_u32 v4, v0, v4
    v_mul_u32_u24 v3, 1152, v3
    v_lshl_add_u32 v5, v4, 4, v3
    v_add_u32 v6, s61, v5
    s_lshl_b32 s62, s26, 10
    s_add_u32 m0, s62, 99328
    v_add_u32 v7, 512, v0
    buffer_load_dwordx4 v6, s[8:11], 0 offen lds
    s_add_u32 m0, s62, 109568
    s_cmp_ge_u32 s26, 3
    buffer_load_dwordx4 v5, s[12:15], s60 offen lds
    s_cbranch_scc1 L_prep_d3
    s_cmp_eq_u32 s26, 2
    s_cbranch_scc1 L_prep_d2
    v_mul_hi_u32 v3, v7, s64
    v_mul_u32_u24 v4, 9, v3
    v_sub_u32 v4, v7, v4
    v_mul_u32_u24 v3, 1152, v3
    v_lshl_add_u32 v5, v4, 4, v3
    v_add_u32 v6, s61, v5
    s_add_u32 m0, s62, 107520
    s_nop 0
    buffer_load_dwordx4 v6, s[8:11], 0 offen lds
    s_branch L_prep_d3
L_prep_d2:
    v_add_u32 v7, 512, v2
    v_mul_hi_u32 v3, v7, s64
    v_mul_u32_u24 v4, 9, v3
    v_sub_u32 v4, v7, v4
    v_mul_u32_u24 v3, 1152, v3
    v_lshl_add_u32 v5, v4, 4, v3
    s_mov_b32 m0, 117760
    s_nop 0
    buffer_load_dwordx4 v5, s[12:15], s60 offen lds
L_prep_d3:
    s_cmp_ge_u32 s26, 5
    s_cbranch_scc1 L_prep_other
    s_mov_b32 s16, s38
    s_mov_b32 s17, s39
    s_mov_b32 s18, 4608
    s_mov_b32 s19, 0x20000
    v_and_b32 v3, 15, v2
    v_lshrrev_b32 v4, 4, v2
    s_mul_i32 s61, s84, 72
    s_lshl_b32 s62, s26, 4
    s_add_u32 s61, s61, s62
    v_add_u32 v5, s61, v3
    v_lshlrev_b32 v5, 3, v5
    buffer_load_dwordx2 v[10:11], v5, s[16:19], 0 offen
    s_cmp_lg_u32 s26, 4
    s_cbranch_scc1 L_prep_k0
    s_cmp_ge_u32 s25, 18
    s_cbranch_scc1 L_prep_k0
    s_mov_b32 s20, s40
    s_mov_b32 s21, s41
    s_mov_b32 s22, 2359296
    s_mov_b32 s23, 0x20000
    s_mul_i32 s63, s24, 18
    s_add_u32 s63, s63, s25
    v_lshlrev_b32 v9, 4, v2
    s_lshl_b32 s63, s63, 2
    s_add_u32 s63, s63, s26
    s_sub_u32 s63, s63, 4
    s_lshl_b32 s63, s63, 12
    buffer_load_dwordx4 v[128:131], v9, s[20:23], s63 offen offset:0
    buffer_load_dwordx4 v[132:135], v9, s[20:23], s63 offen offset:8
    buffer_load_dwordx4 v[136:139], v9, s[20:23], s63 offen offset:1024
    buffer_load_dwordx4 v[140:143], v9, s[20:23], s63 offen offset:1032
    buffer_load_dwordx4 v[144:147], v9, s[20:23], s63 offen offset:2048
    buffer_load_dwordx4 v[148:151], v9, s[20:23], s63 offen offset:2056
    buffer_load_dwordx4 v[152:155], v9, s[20:23], s63 offen offset:3072
    buffer_load_dwordx4 v[156:159], v9, s[20:23], s63 offen offset:3080
    s_waitcnt vmcnt(8)
    s_branch L_prep_k1
L_prep_k0:
    s_waitcnt vmcnt(0)
L_prep_k1:
    v_bfe_u32 v5, v2, 2, 2
    v_lshl_add_u32 v5, v4, 3, v5
    v_mul_u32_u24 v5, 144, v5
    v_and_b32 v6, 3, v2
    v_lshl_add_u32 v5, v6, 3, v5
    s_lshl_b32 s62, s26, 5
    s_add_u32 s62, s62, 99328
    v_add_u32 v5, s62, v5
    s_waitcnt lgkmcnt(0)
    s_barrier
    ds_read_b64_tr_b16 v[12:13], v5 offset:0
    ds_read_b64_tr_b16 v[14:15], v5 offset:576
    ds_read_b64_tr_b16 v[16:17], v5 offset:1152
    ds_read_b64_tr_b16 v[24:25], v5 offset:10240
    ds_read_b64_tr_b16 v[26:27], v5 offset:10816
    ds_read_b64_tr_b16 v[18:19], v5 offset:4608
    ds_read_b64_tr_b16 v[20:21], v5 offset:5184
    ds_read_b64_tr_b16 v[22:23], v5 offset:5760
    ds_read_b64_tr_b16 v[28:29], v5 offset:14848
    ds_read_b64_tr_b16 v[30:31], v5 offset:15424
    s_mov_b32 s65, 0xffff0000
    v_lshlrev_b32 v72, 16, v10
    v_and_b32 v73, s65, v10
    v_lshlrev_b32 v74, 16, v11
    v_and_b32 v75, s65, v11
    v_lshlrev_b32 v6, 12, v3
    v_lshl_add_u32 v6, v4, 4, v6
    v_mov_b32 v7, 0x7fffffff
    s_mul_i32 s62, s26, 16
    v_add_u32 v8, s62, v3
    v_cmp_gt_u32 vcc, 72, v8
    s_lshl_b32 s62, s61, 12
    s_lshl_b32 s63, s85, 7
    s_add_u32 s62, s62, s63
    s_add_u32 s62, s62, 2162688
    v_cndmask_b32 v6, v7, v6, vcc
    s_waitcnt lgkmcnt(7)
    v_and_b32 v33, s65, v12
    v_lshlrev_b32 v34, 16, v13
    v_and_b32 v35, s65, v13
    v_lshlrev_b32 v36, 16, v14
    v_and_b32 v37, s65, v14
    v_lshlrev_b32 v38, 16, v15
    v_and_b32 v39, s65, v15
    v_lshlrev_b32 v40, 16, v16
    v_and_b32 v41, s65, v16
    v_lshlrev_b32 v42, 16, v17
    v_and_b32 v43, s65, v17
    v_mul_f32 v56, v72, v36
    v_mul_f32 v57, v72, v37
    v_mul_f32 v58, v72, v38
    v_mul_f32 v59, v72, v39
    v_mul_f32 v60, v72, v40
    v_mul_f32 v61, v72, v41
    v_mul_f32 v62, v72, v42
    v_mul_f32 v63, v72, v43
    v_fmac_f32 v56, v73, v35
    v_fmac_f32 v57, v73, v36
    v_fmac_f32 v58, v73, v37
    v_fmac_f32 v59, v73, v38
    v_fmac_f32 v60, v73, v39
    v_fmac_f32 v61, v73, v40
    v_fmac_f32 v62, v73, v41
    v_fmac_f32 v63, v73, v42
    v_fmac_f32 v56, v74, v34
    v_fmac_f32 v57, v74, v35
    v_fmac_f32 v58, v74, v36
    v_fmac_f32 v59, v74, v37
    v_fmac_f32 v60, v74, v38
    v_fmac_f32 v61, v74, v39
    v_fmac_f32 v62, v74, v40
    v_fmac_f32 v63, v74, v41
    v_fmac_f32 v56, v75, v33
    v_fmac_f32 v57, v75, v34
    v_fmac_f32 v58, v75, v35
    v_fmac_f32 v59, v75, v36
    v_fmac_f32 v60, v75, v37
    v_fmac_f32 v61, v75, v38
    v_fmac_f32 v62, v75, v39
    v_fmac_f32 v63, v75, v40
    s_waitcnt lgkmcnt(5)
    v_lshlrev_b32 v32, 16, v24
    v_and_b32 v33, s65, v24
    v_lshlrev_b32 v34, 16, v25
    v_and_b32 v35, s65, v25
    v_lshlrev_b32 v36, 16, v26
    v_and_b32 v37, s65, v26
    v_lshlrev_b32 v38, 16, v27
    v_and_b32 v39, s65, v27
    v_mul_f32 v56, v56, v32
    v_mul_f32 v57, v57, v33
    v_mul_f32 v58, v58, v34
    v_mul_f32 v59, v59, v35
    v_mul_f32 v60, v60, v36
    v_mul_f32 v61, v61, v37
    v_mul_f32 v62, v62, v38
    v_mul_f32 v63, v63, v39
    v_cvt_pk_bf16_f32 v76, v63, v62
    v_cvt_pk_bf16_f32 v77, v61, v60
    v_cvt_pk_bf16_f32 v78, v59, v58
    v_cvt_pk_bf16_f32 v79, v57, v56
    buffer_store_dwordx4 v[76:79], v6, s[4:7], s62 offen offset:0 sc1
    s_waitcnt lgkmcnt(2)
    v_and_b32 v45, s65, v18
    v_lshlrev_b32 v46, 16, v19
    v_and_b32 v47, s65, v19
    v_lshlrev_b32 v48, 16, v20
    v_and_b32 v49, s65, v20
    v_lshlrev_b32 v50, 16, v21
    v_and_b32 v51, s65, v21
    v_lshlrev_b32 v52, 16, v22
    v_and_b32 v53, s65, v22
    v_lshlrev_b32 v54, 16, v23
    v_and_b32 v55, s65, v23
    v_mul_f32 v64, v72, v48
    v_mul_f32 v65, v72, v49
    v_mul_f32 v66, v72, v50
    v_mul_f32 v67, v72, v51
    v_mul_f32 v68, v72, v52
    v_mul_f32 v69, v72, v53
    v_mul_f32 v70, v72, v54
    v_mul_f32 v71, v72, v55
    v_fmac_f32 v64, v73, v47
    v_fmac_f32 v65, v73, v48
    v_fmac_f32 v66, v73, v49
    v_fmac_f32 v67, v73, v50
    v_fmac_f32 v68, v73, v51
    v_fmac_f32 v69, v73, v52
    v_fmac_f32 v70, v73, v53
    v_fmac_f32 v71, v73, v54
    v_fmac_f32 v64, v74, v46
    v_fmac_f32 v65, v74, v47
    v_fmac_f32 v66, v74, v48
    v_fmac_f32 v67, v74, v49
    v_fmac_f32 v68, v74, v50
    v_fmac_f32 v69, v74, v51
    v_fmac_f32 v70, v74, v52
    v_fmac_f32 v71, v74, v53
    v_fmac_f32 v64, v75, v45
    v_fmac_f32 v65, v75, v46
    v_fmac_f32 v66, v75, v47
    v_fmac_f32 v67, v75, v48
    v_fmac_f32 v68, v75, v49
    v_fmac_f32 v69, v75, v50
    v_fmac_f32 v70, v75, v51
    v_fmac_f32 v71, v75, v52
    s_waitcnt lgkmcnt(0)
    v_lshlrev_b32 v44, 16, v28
    v_and_b32 v45, s65, v28
    v_lshlrev_b32 v46, 16, v29
    v_and_b32 v47, s65, v29
    v_lshlrev_b32 v48, 16, v30
    v_and_b32 v49, s65, v30
    v_lshlrev_b32 v50, 16, v31
    v_and_b32 v51, s65, v31
    v_mul_f32 v64, v64, v44
    v_mul_f32 v65, v65, v45
    v_mul_f32 v66, v66, v46
    v_mul_f32 v67, v67, v47
    v_mul_f32 v68, v68, v48
    v_mul_f32 v69, v69, v49
    v_mul_f32 v70, v70, v50
    v_mul_f32 v71, v71, v51
    v_cvt_pk_bf16_f32 v80, v71, v70
    v_cvt_pk_bf16_f32 v81, v69, v68
    v_cvt_pk_bf16_f32 v82, v67, v66
    v_cvt_pk_bf16_f32 v83, v65, v64
    buffer_store_dwordx4 v[80:83], v6, s[4:7], s62 offen offset:64 sc1
    s_add_u32 s28, s28, 1
    s_addc_u32 s29, s29, 0
    s_lshl_b32 s60, s84, 5
    s_add_u32 s60, s60, s85
    s_lshl_b32 s60, s60, 6
    s_add_u32 s60, s60, 4096
    v_mov_b32 v10, s28
    v_mov_b32 v11, s29
    v_mov_b32 v12, 0
    s_mov_b32 s81, 256
    s_cmp_lg_u32 s26, 0
    s_waitcnt vmcnt(0)
    s_barrier
    s_cbranch_scc1 L_prep_nf
    s_mov_b64 exec, 1
    buffer_store_dwordx2 v[10:11], v12, s[4:7], s60 offen sc1
    s_mov_b64 exec, -1
L_prep_nf:
    s_cmp_lt_u32 s26, 4
    s_cbranch_scc1 L_prep_done
    s_branch L_prep_second
L_prep_other:
    s_mul_i32 s70, s24, 14
    s_add_u32 s70, s70, s25
    s_sub_u32 s70, s70, 18
    s_cmp_ge_u32 s25, 18
    s_cbranch_scc1 L_prep_r
    s_lshl_b32 s81, s24, 4
    s_add_u32 s81, s81, s25
    s_cmp_lt_u32 s25, 16
    s_cselect_b32 s81, s81, 256
    s_cmp_eq_u32 s26, 5
    s_cselect_b32 s81, s81, 256
    s_mov_b32 s20, s40
    s_mov_b32 s21, s41
    s_mov_b32 s22, 2359296
    s_mov_b32 s23, 0x20000
    s_mul_i32 s63, s24, 18
    s_add_u32 s63, s63, s25
    v_lshlrev_b32 v9, 4, v2
    s_lshl_b32 s63, s63, 2
    s_add_u32 s63, s63, s26
    s_sub_u32 s63, s63, 4
    s_lshl_b32 s63, s63, 12
    buffer_load_dwordx4 v[128:131], v9, s[20:23], s63 offen offset:0
    buffer_load_dwordx4 v[132:135], v9, s[20:23], s63 offen offset:8
    buffer_load_dwordx4 v[136:139], v9, s[20:23], s63 offen offset:1024
    buffer_load_dwordx4 v[140:143], v9, s[20:23], s63 offen offset:1032
    buffer_load_dwordx4 v[144:147], v9, s[20:23], s63 offen offset:2048
    buffer_load_dwordx4 v[148:151], v9, s[20:23], s63 offen offset:2056
    buffer_load_dwordx4 v[152:155], v9, s[20:23], s63 offen offset:3072
    buffer_load_dwordx4 v[156:159], v9, s[20:23], s63 offen offset:3080
    s_cmp_lt_u32 s81, 128
    s_cbranch_scc1 L_prep_hx
    s_waitcnt vmcnt(8) lgkmcnt(0)
    s_branch L_prep_w1
L_prep_hx:
    s_mov_b32 s16, s32
    s_mov_b32 s17, s33
    s_mov_b32 s18, 2359296
    s_mov_b32 s19, 0x20000
    s_mul_i32 s61, s81, 18432
    v_lshrrev_b32 v24, 3, v2
    v_and_b32 v25, 7, v2
    v_mul_u32_u24 v26, 2304, v24
    v_lshl_add_u32 v26, v25, 4, v26
    buffer_load_dwordx4 v[168:171], v26, s[16:19], s61 offen offset:0
    buffer_load_dwordx4 v[172:175], v26, s[16:19], s61 offen offset:1152
    buffer_load_dwordx4 v[176:179], v26, s[16:19], s61 offen offset:128
    buffer_load_dwordx4 v[180:183], v26, s[16:19], s61 offen offset:1280
    buffer_load_dwordx4 v[184:187], v26, s[16:19], s61 offen offset:256
    buffer_load_dwordx4 v[188:191], v26, s[16:19], s61 offen offset:1408
    buffer_load_dwordx4 v[192:195], v26, s[16:19], s61 offen offset:384
    buffer_load_dwordx4 v[196:199], v26, s[16:19], s61 offen offset:1536
    buffer_load_dwordx4 v[200:203], v26, s[16:19], s61 offen offset:512
    buffer_load_dwordx4 v[204:207], v26, s[16:19], s61 offen offset:1664
    buffer_load_dwordx4 v[208:211], v26, s[16:19], s61 offen offset:640
    buffer_load_dwordx4 v[212:215], v26, s[16:19], s61 offen offset:1792
    buffer_load_dwordx4 v[216:219], v26, s[16:19], s61 offen offset:768
    buffer_load_dwordx4 v[220:223], v26, s[16:19], s61 offen offset:1920
    buffer_load_dwordx4 v[224:227], v26, s[16:19], s61 offen offset:896
    buffer_load_dwordx4 v[228:231], v26, s[16:19], s61 offen offset:2048
    buffer_load_dwordx4 v[232:235], v26, s[16:19], s61 offen offset:1024
    buffer_load_dwordx4 v[236:239], v26, s[16:19], s61 offen offset:2176
    s_waitcnt vmcnt(26) lgkmcnt(0)
    s_branch L_prep_w1
L_prep_r:
    s_cmp_ge_u32 s70, 72
    s_cbranch_scc1 L_prep_w0
    s_cmp_lt_u32 s26, 6
    s_cbranch_scc1 L_prep_w0
    s_mul_i32 s70, s24, 14
    s_add_u32 s70, s70, s25
    s_sub_u32 s70, s70, 18
    s_sub_u32 s62, s26, 6
    s_lshr_b32 s71, s70, 1
    s_and_b32 s72, s70, 1
    s_mul_i32 s60, s71, 55296
    s_mul_i32 s61, s72, 576
    s_add_u32 s60, s60, s61
    s_add_u32 s60, s60, 0
    s_mov_b32 s12, s46
    s_mov_b32 s13, s47
    s_mov_b32 s14, 1990656
    s_mov_b32 s15, 0x20000
L_1:
    v_lshl_add_u32 v4, s62, 6, v2
    v_lshrrev_b32 v7, 2, v4
    v_mul_hi_u32 v5, v7, s64
    v_mul_u32_u24 v6, 9, v5
    v_sub_u32 v6, v7, v6
    v_mul_u32_u24 v5, 576, v5
    v_lshl_add_u32 v8, v4, 4, v5
    s_lshl_b32 s63, s62, 10
    s_add_u32 m0, s63, 0
    s_add_u32 s62, s62, 2
    buffer_load_dwordx4 v8, s[12:15], s60 offen lds
    s_cmp_lt_u32 s62, 27
    s_cbranch_scc1 L_1
    s_waitcnt vmcnt(13) lgkmcnt(0)
    s_branch L_prep_w1
L_prep_w0:
    s_waitcnt vmcnt(0) lgkmcnt(0)
L_prep_w1:
    s_barrier
    s_add_u32 s28, s28, 1
    s_addc_u32 s29, s29, 0
    s_barrier
L_prep_second:
    s_sub_u32 s67, s26, 4
    s_cmp_ge_u32 s25, 18
    s_cbranch_scc1 L_prep_done
    s_waitcnt vmcnt(0)
    s_cmp_ge_u32 s81, 128
    s_cbranch_scc1 L_prep_b2
    v_mov_b32 v28, 0
    v_mov_b32 v29, 0
    v_mov_b32 v30, 0
    v_mov_b32 v31, 0
    v_mov_b32 v27, 0x3f803f80
    s_waitcnt vmcnt(0)
    v_dot2c_f32_bf16 v28, v168, v27
    v_dot2c_f32_bf16 v29, v168, v168
    v_dot2c_f32_bf16 v30, v172, v27
    v_dot2c_f32_bf16 v31, v172, v172
    v_dot2c_f32_bf16 v28, v169, v27
    v_dot2c_f32_bf16 v29, v169, v169
    v_dot2c_f32_bf16 v30, v173, v27
    v_dot2c_f32_bf16 v31, v173, v173
    v_dot2c_f32_bf16 v28, v170, v27
    v_dot2c_f32_bf16 v29, v170, v170
    v_dot2c_f32_bf16 v30, v174, v27
    v_dot2c_f32_bf16 v31, v174, v174
    v_dot2c_f32_bf16 v28, v171, v27
    v_dot2c_f32_bf16 v29, v171, v171
    v_dot2c_f32_bf16 v30, v175, v27
    v_dot2c_f32_bf16 v31, v175, v175
    v_swap_b32 v170, v172
    v_swap_b32 v171, v173
    v_dot2c_f32_bf16 v28, v176, v27
    v_dot2c_f32_bf16 v29, v176, v176
    v_dot2c_f32_bf16 v30, v180, v27
    v_dot2c_f32_bf16 v31, v180, v180
    v_dot2c_f32_bf16 v28, v177, v27
    v_dot2c_f32_bf16 v29, v177, v177
    v_dot2c_f32_bf16 v30, v181, v27
    v_dot2c_f32_bf16 v31, v181, v181
    v_dot2c_f32_bf16 v28, v178, v27
    v_dot2c_f32_bf16 v29, v178, v178
    v_dot2c_f32_bf16 v30, v182, v27
    v_dot2c_f32_bf16 v31, v182, v182
    v_dot2c_f32_bf16 v28, v179, v27
    v_dot2c_f32_bf16 v29, v179, v179
    v_dot2c_f32_bf16 v30, v183, v27
    v_dot2c_f32_bf16 v31, v183, v183
    v_swap_b32 v178, v180
    v_swap_b32 v179, v181
    v_dot2c_f32_bf16 v28, v184, v27
    v_dot2c_f32_bf16 v29, v184, v184
    v_dot2c_f32_bf16 v30, v188, v27
    v_dot2c_f32_bf16 v31, v188, v188
    v_dot2c_f32_bf16 v28, v185, v27
    v_dot2c_f32_bf16 v29, v185, v185
    v_dot2c_f32_bf16 v30, v189, v27
    v_dot2c_f32_bf16 v31, v189, v189
    v_dot2c_f32_bf16 v28, v186, v27
    v_dot2c_f32_bf16 v29, v186, v186
    v_dot2c_f32_bf16 v30, v190, v27
    v_dot2c_f32_bf16 v31, v190, v190
    v_dot2c_f32_bf16 v28, v187, v27
    v_dot2c_f32_bf16 v29, v187, v187
    v_dot2c_f32_bf16 v30, v191, v27
    v_dot2c_f32_bf16 v31, v191, v191
    v_swap_b32 v186, v188
    v_swap_b32 v187, v189
    v_dot2c_f32_bf16 v28, v192, v27
    v_dot2c_f32_bf16 v29, v192, v192
    v_dot2c_f32_bf16 v30, v196, v27
    v_dot2c_f32_bf16 v31, v196, v196
    v_dot2c_f32_bf16 v28, v193, v27
    v_dot2c_f32_bf16 v29, v193, v193
    v_dot2c_f32_bf16 v30, v197, v27
    v_dot2c_f32_bf16 v31, v197, v197
    v_dot2c_f32_bf16 v28, v194, v27
    v_dot2c_f32_bf16 v29, v194, v194
    v_dot2c_f32_bf16 v30, v198, v27
    v_dot2c_f32_bf16 v31, v198, v198
    v_dot2c_f32_bf16 v28, v195, v27
    v_dot2c_f32_bf16 v29, v195, v195
    v_dot2c_f32_bf16 v30, v199, v27
    v_dot2c_f32_bf16 v31, v199, v199
    v_swap_b32 v194, v196
    v_swap_b32 v195, v197
    v_dot2c_f32_bf16 v28, v200, v27
    v_dot2c_f32_bf16 v29, v200, v200
    v_dot2c_f32_bf16 v30, v204, v27
    v_dot2c_f32_bf16 v31, v204, v204
    v_dot2c_f32_bf16 v28, v201, v27
    v_dot2c_f32_bf16 v29, v201, v201
    v_dot2c_f32_bf16 v30, v205, v27
    v_dot2c_f32_bf16 v31, v205, v205
    v_dot2c_f32_bf16 v28, v202, v27
    v_dot2c_f32_bf16 v29, v202, v202
    v_dot2c_f32_bf16 v30, v206, v27
    v_dot2c_f32_bf16 v31, v206, v206
    v_dot2c_f32_bf16 v28, v203, v27
    v_dot2c_f32_bf16 v29, v203, v203
    v_dot2c_f32_bf16 v30, v207, v27
    v_dot2c_f32_bf16 v31, v207, v207
    v_swap_b32 v202, v204
    v_swap_b32 v203, v205
    v_dot2c_f32_bf16 v28, v208, v27
    v_dot2c_f32_bf16 v29, v208, v208
    v_dot2c_f32_bf16 v30, v212, v27
    v_dot2c_f32_bf16 v31, v212, v212
    v_dot2c_f32_bf16 v28, v209, v27
    v_dot2c_f32_bf16 v29, v209, v209
    v_dot2c_f32_bf16 v30, v213, v27
    v_dot2c_f32_bf16 v31, v213, v213
    v_dot2c_f32_bf16 v28, v210, v27
    v_dot2c_f32_bf16 v29, v210, v210
    v_dot2c_f32_bf16 v30, v214, v27
    v_dot2c_f32_bf16 v31, v214, v214
    v_dot2c_f32_bf16 v28, v211, v27
    v_dot2c_f32_bf16 v29, v211, v211
    v_dot2c_f32_bf16 v30, v215, v27
    v_dot2c_f32_bf16 v31, v215, v215
    v_swap_b32 v210, v212
    v_swap_b32 v211, v213
    v_dot2c_f32_bf16 v28, v216, v27
    v_dot2c_f32_bf16 v29, v216, v216
    v_dot2c_f32_bf16 v30, v220, v27
    v_dot2c_f32_bf16 v31, v220, v220
    v_dot2c_f32_bf16 v28, v217, v27
    v_dot2c_f32_bf16 v29, v217, v217
    v_dot2c_f32_bf16 v30, v221, v27
    v_dot2c_f32_bf16 v31, v221, v221
    v_dot2c_f32_bf16 v28, v218, v27
    v_dot2c_f32_bf16 v29, v218, v218
    v_dot2c_f32_bf16 v30, v222, v27
    v_dot2c_f32_bf16 v31, v222, v222
    v_dot2c_f32_bf16 v28, v219, v27
    v_dot2c_f32_bf16 v29, v219, v219
    v_dot2c_f32_bf16 v30, v223, v27
    v_dot2c_f32_bf16 v31, v223, v223
    v_swap_b32 v218, v220
    v_swap_b32 v219, v221
    v_dot2c_f32_bf16 v28, v224, v27
    v_dot2c_f32_bf16 v29, v224, v224
    v_dot2c_f32_bf16 v30, v228, v27
    v_dot2c_f32_bf16 v31, v228, v228
    v_dot2c_f32_bf16 v28, v225, v27
    v_dot2c_f32_bf16 v29, v225, v225
    v_dot2c_f32_bf16 v30, v229, v27
    v_dot2c_f32_bf16 v31, v229, v229
    v_dot2c_f32_bf16 v28, v226, v27
    v_dot2c_f32_bf16 v29, v226, v226
    v_dot2c_f32_bf16 v30, v230, v27
    v_dot2c_f32_bf16 v31, v230, v230
    v_dot2c_f32_bf16 v28, v227, v27
    v_dot2c_f32_bf16 v29, v227, v227
    v_dot2c_f32_bf16 v30, v231, v27
    v_dot2c_f32_bf16 v31, v231, v231
    v_swap_b32 v226, v228
    v_swap_b32 v227, v229
    v_dot2c_f32_bf16 v28, v232, v27
    v_dot2c_f32_bf16 v29, v232, v232
    v_dot2c_f32_bf16 v30, v236, v27
    v_dot2c_f32_bf16 v31, v236, v236
    v_dot2c_f32_bf16 v28, v233, v27
    v_dot2c_f32_bf16 v29, v233, v233
    v_dot2c_f32_bf16 v30, v237, v27
    v_dot2c_f32_bf16 v31, v237, v237
    v_dot2c_f32_bf16 v28, v234, v27
    v_dot2c_f32_bf16 v29, v234, v234
    v_dot2c_f32_bf16 v30, v238, v27
    v_dot2c_f32_bf16 v31, v238, v238
    v_dot2c_f32_bf16 v28, v235, v27
    v_dot2c_f32_bf16 v29, v235, v235
    v_dot2c_f32_bf16 v30, v239, v27
    v_dot2c_f32_bf16 v31, v239, v239
    v_swap_b32 v234, v236
    v_swap_b32 v235, v237
    v_add_f32_dpp v28, v28, v28 quad_perm:[1,0,3,2] row_mask:0xf bank_mask:0xf bound_ctrl:0
    v_add_f32_dpp v29, v29, v29 quad_perm:[1,0,3,2] row_mask:0xf bank_mask:0xf bound_ctrl:0
    v_add_f32_dpp v30, v30, v30 quad_perm:[1,0,3,2] row_mask:0xf bank_mask:0xf bound_ctrl:0
    v_add_f32_dpp v31, v31, v31 quad_perm:[1,0,3,2] row_mask:0xf bank_mask:0xf bound_ctrl:0
    v_add_f32_dpp v28, v28, v28 quad_perm:[2,3,0,1] row_mask:0xf bank_mask:0xf bound_ctrl:0
    v_add_f32_dpp v29, v29, v29 quad_perm:[2,3,0,1] row_mask:0xf bank_mask:0xf bound_ctrl:0
    v_add_f32_dpp v30, v30, v30 quad_perm:[2,3,0,1] row_mask:0xf bank_mask:0xf bound_ctrl:0
    v_add_f32_dpp v31, v31, v31 quad_perm:[2,3,0,1] row_mask:0xf bank_mask:0xf bound_ctrl:0
    v_add_f32_dpp v28, v28, v28 row_half_mirror row_mask:0xf bank_mask:0xf bound_ctrl:0
    v_add_f32_dpp v29, v29, v29 row_half_mirror row_mask:0xf bank_mask:0xf bound_ctrl:0
    v_add_f32_dpp v30, v30, v30 row_half_mirror row_mask:0xf bank_mask:0xf bound_ctrl:0
    v_add_f32_dpp v31, v31, v31 row_half_mirror row_mask:0xf bank_mask:0xf bound_ctrl:0
    v_mul_f32 v28, 0x3ae38e39, v28
    v_mul_f32 v29, 0x3ae38e39, v29
    v_fma_f32 v27, -v28, v28, v29
    v_max_f32 v27, 0, v27
    v_add_f32 v27, 0x3727c5ac, v27
    v_rsq_f32 v32, v27
    s_nop 0
    v_mul_f32 v33, v28, v32
    v_sub_f32 v33, 0, v33
    v_mul_f32 v30, 0x3ae38e39, v30
    v_mul_f32 v31, 0x3ae38e39, v31
    v_fma_f32 v27, -v30, v30, v31
    v_max_f32 v27, 0, v27
    v_add_f32 v27, 0x3727c5ac, v27
    v_rsq_f32 v34, v27
    s_nop 0
    v_mul_f32 v35, v30, v34
    v_sub_f32 v35, 0, v35
    s_lshl_b32 s82, s81, 6
    s_add_u32 s82, s82, 442368
    s_lshl_b32 s63, s81, 7
    s_add_u32 s63, s63, 720896
    v_lshlrev_b32 v24, 4, v24
    v_lshl_add_u32 v26, v25, 9, v24
    v_cmp_eq_u32 vcc, 0, v25
    s_lshr_b32 s60, s81, 1
    s_mul_i32 s60, s60, 36864
    s_and_b32 s61, s81, 1
    s_lshl_b32 s61, s61, 7
    s_add_u32 s60, s60, s61
    s_add_u32 s60, s60, 33554432
    s_mov_b64 exec, vcc
    buffer_store_dwordx4 v[32:35], v24, s[4:7], s63 offen sc1
    s_mov_b64 exec, -1
    buffer_store_dwordx4 v[168:171], v26, s[4:7], s60 offen sc1
    buffer_store_dwordx4 v[172:175], v26, s[4:7], s60 offen offset:256 sc1
    s_add_u32 s60, s60, 4096
    buffer_store_dwordx4 v[176:179], v26, s[4:7], s60 offen sc1
    buffer_store_dwordx4 v[180:183], v26, s[4:7], s60 offen offset:256 sc1
    s_add_u32 s60, s60, 4096
    buffer_store_dwordx4 v[184:187], v26, s[4:7], s60 offen sc1
    buffer_store_dwordx4 v[188:191], v26, s[4:7], s60 offen offset:256 sc1
    s_add_u32 s60, s60, 4096
    buffer_store_dwordx4 v[192:195], v26, s[4:7], s60 offen sc1
    buffer_store_dwordx4 v[196:199], v26, s[4:7], s60 offen offset:256 sc1
    s_add_u32 s60, s60, 4096
    buffer_store_dwordx4 v[200:203], v26, s[4:7], s60 offen sc1
    buffer_store_dwordx4 v[204:207], v26, s[4:7], s60 offen offset:256 sc1
    s_add_u32 s60, s60, 4096
    buffer_store_dwordx4 v[208:211], v26, s[4:7], s60 offen sc1
    buffer_store_dwordx4 v[212:215], v26, s[4:7], s60 offen offset:256 sc1
    s_add_u32 s60, s60, 4096
    buffer_store_dwordx4 v[216:219], v26, s[4:7], s60 offen sc1
    buffer_store_dwordx4 v[220:223], v26, s[4:7], s60 offen offset:256 sc1
    s_add_u32 s60, s60, 4096
    buffer_store_dwordx4 v[224:227], v26, s[4:7], s60 offen sc1
    buffer_store_dwordx4 v[228:231], v26, s[4:7], s60 offen offset:256 sc1
    s_add_u32 s60, s60, 4096
    buffer_store_dwordx4 v[232:235], v26, s[4:7], s60 offen sc1
    buffer_store_dwordx4 v[236:239], v26, s[4:7], s60 offen offset:256 sc1
L_prep_b2:
    s_mov_b32 s61, s67
    s_mul_i32 s63, s61, 16640
    s_add_u32 s63, s63, 32
    v_lshl_add_u32 v7, v2, 4, s63
    v_readlane_b32 s60, v128, 0
    v_readlane_b32 s62, v129, 0
    ds_write_b128 v7, v[128:131] offset:0
    v_alignbyte_b32 v84, v129, v128, 2
    v_alignbyte_b32 v85, v130, v129, 2
    v_alignbyte_b32 v86, v131, v130, 2
    v_alignbyte_b32 v87, v134, v131, 2
    ds_write_b128 v7, v[84:87] offset:4160
    v_mov_b32 v88, v129
    v_mov_b32 v89, v130
    v_mov_b32 v90, v131
    v_mov_b32 v91, v134
    ds_write_b128 v7, v[88:91] offset:8320
    v_alignbyte_b32 v92, v130, v129, 2
    v_alignbyte_b32 v93, v131, v130, 2
    v_alignbyte_b32 v94, v134, v131, 2
    v_alignbyte_b32 v95, v135, v134, 2
    ds_write_b128 v7, v[92:95] offset:12480
    ds_write_b128 v7, v[136:139] offset:1024
    v_alignbyte_b32 v96, v137, v136, 2
    v_alignbyte_b32 v97, v138, v137, 2
    v_alignbyte_b32 v98, v139, v138, 2
    v_alignbyte_b32 v99, v142, v139, 2
    ds_write_b128 v7, v[96:99] offset:5184
    v_mov_b32 v100, v137
    v_mov_b32 v101, v138
    v_mov_b32 v102, v139
    v_mov_b32 v103, v142
    ds_write_b128 v7, v[100:103] offset:9344
    v_alignbyte_b32 v104, v138, v137, 2
    v_alignbyte_b32 v105, v139, v138, 2
    v_alignbyte_b32 v106, v142, v139, 2
    v_alignbyte_b32 v107, v143, v142, 2
    ds_write_b128 v7, v[104:107] offset:13504
    ds_write_b128 v7, v[144:147] offset:2048
    v_alignbyte_b32 v84, v145, v144, 2
    v_alignbyte_b32 v85, v146, v145, 2
    v_alignbyte_b32 v86, v147, v146, 2
    v_alignbyte_b32 v87, v150, v147, 2
    ds_write_b128 v7, v[84:87] offset:6208
    v_mov_b32 v88, v145
    v_mov_b32 v89, v146
    v_mov_b32 v90, v147
    v_mov_b32 v91, v150
    ds_write_b128 v7, v[88:91] offset:10368
    v_alignbyte_b32 v92, v146, v145, 2
    v_alignbyte_b32 v93, v147, v146, 2
    v_alignbyte_b32 v94, v150, v147, 2
    v_alignbyte_b32 v95, v151, v150, 2
    ds_write_b128 v7, v[92:95] offset:14528
    ds_write_b128 v7, v[152:155] offset:3072
    v_alignbyte_b32 v96, v153, v152, 2
    v_alignbyte_b32 v97, v154, v153, 2
    v_alignbyte_b32 v98, v155, v154, 2
    v_alignbyte_b32 v99, v158, v155, 2
    ds_write_b128 v7, v[96:99] offset:7232
    v_mov_b32 v100, v153
    v_mov_b32 v101, v154
    v_mov_b32 v102, v155
    v_mov_b32 v103, v158
    ds_write_b128 v7, v[100:103] offset:11392
    v_alignbyte_b32 v104, v154, v153, 2
    v_alignbyte_b32 v105, v155, v154, 2
    v_alignbyte_b32 v106, v158, v155, 2
    v_alignbyte_b32 v107, v159, v158, 2
    ds_write_b128 v7, v[104:107] offset:15552
    v_mov_b32 v16, s60
    v_mov_b32 v17, s62
    v_mov_b32 v18, 0
    v_mov_b32 v19, 0
    v_mov_b32 v20, 0
    v_mov_b32 v21, 0
    v_lshlrev_b32 v8, 4, v2
    v_sub_u32 v8, 64, v8
    v_cmp_eq_u32 vcc, 0, v2
    v_lshlrev_b64 v[22:23], v8, v[16:17]
    s_sub_u32 s63, s63, 32
    v_mul_u32_u24 v7, 4160, v2
    v_add_u32 v7, s63, v7
    v_cndmask_b32 v22, v22, v18, vcc
    v_cndmask_b32 v23, v23, v18, vcc
    s_mul_i32 s63, s61, 4608
    s_add_u32 s63, s63, 66560
    v_lshl_add_u32 v8, v2, 3, s63
    ds_write_b64 v8, v[18:19]
    s_mov_b64 exec, 15
    ds_write_b128 v7, v[18:21]
    ds_write_b128 v7, v[20:23] offset:16
    s_mov_b64 exec, -1
    s_cmp_ge_u32 s81, 128
    s_cbranch_scc1 L_prep_b3
    s_waitcnt vmcnt(0)
    v_mov_b32 v10, s28
    v_mov_b32 v11, s29
    v_mov_b32 v12, 0
    s_mov_b64 exec, 1
    buffer_store_dwordx2 v[10:11], v12, s[4:7], s82 offen sc1
    s_mov_b64 exec, -1
L_prep_b3:
    s_waitcnt lgkmcnt(0)
    s_barrier
L_prep_done:
    s_cmp_ge_u32 s25, 18
    s_cbranch_scc1 L_relayout
    s_mul_i32 s66, s24, 18
    s_add_u32 s66, s66, s25
    s_cmp_ge_u32 s26, 4
    s_cbranch_scc1 L_conv_help
    s_mov_b32 s8, s42
    s_mov_b32 s9, s43
    s_mov_b32 s10, 1152
    s_mov_b32 s11, 0x20000
    s_lshl_b32 s61, s66, 2
    s_add_u32 s61, s61, s26
    s_lshl_b32 s62, s61, 1
    v_mov_b32 v4, s62
    buffer_load_ushort v5, v4, s[8:11], 0 offen
    s_mul_i32 s62, s26, 4608
    s_add_u32 s62, s62, 67072
    s_cmp_lg_u32 s26, 0
    s_cbranch_scc1 L_conv_nu
    v_and_b32 v4, 31, v2
    v_lshlrev_b32 v4, 6, v4
    s_lshl_b32 s60, s24, 11
    s_add_u32 s60, s60, 4096
    s_waitcnt vmcnt(0)
    s_mov_b32 s96, 400000
Lpoll_3:
    buffer_load_dwordx2 v[176:177], v4, s[4:7], s60 offen offset:0 sc1
    s_waitcnt vmcnt(0)
    v_cmp_ne_u64 vcc, s[28:29], v[176:177]
    s_nop 0
    s_cmp_eq_u64 vcc, 0
    s_cbranch_scc1 Lpolld_4
    s_mov_b64 exec, vcc
    s_sub_u32 s96, s96, 1
    s_cmp_lg_u32 s96, 0
    s_cbranch_scc1 Lpoll_3
    v_mov_b32 v176, 1
    v_mov_b32 v177, 0
    global_store_dword v177, v176, s[52:53]
    s_waitcnt vmcnt(0)
Lpolld_4:
    s_mov_b64 exec, -1
    s_lshl_b32 s61, s61, 12
    s_add_u32 s61, s61, 2162688
    v_lshlrev_b32 v4, 4, v2
    s_mov_b32 m0, 67072
    s_add_u32 s63, s61, 0
    buffer_load_dwordx4 v4, s[4:7], s63 offen sc1 lds
    s_mov_b32 m0, 68096
    s_add_u32 s63, s61, 1024
    buffer_load_dwordx4 v4, s[4:7], s63 offen sc1 lds
    s_mov_b32 m0, 69120
    s_add_u32 s63, s61, 2048
    buffer_load_dwordx4 v4, s[4:7], s63 offen sc1 lds
    s_mov_b32 m0, 70144
    s_add_u32 s63, s61, 3072
    buffer_load_dwordx4 v4, s[4:7], s63 offen sc1 lds
    s_mov_b32 m0, 71680
    s_add_u32 s63, s61, 4096
    buffer_load_dwordx4 v4, s[4:7], s63 offen sc1 lds
    s_mov_b32 m0, 72704
    s_add_u32 s63, s61, 5120
    buffer_load_dwordx4 v4, s[4:7], s63 offen sc1 lds
    s_mov_b32 m0, 73728
    s_add_u32 s63, s61, 6144
    buffer_load_dwordx4 v4, s[4:7], s63 offen sc1 lds
    s_mov_b32 m0, 74752
    s_add_u32 s63, s61, 7168
    buffer_load_dwordx4 v4, s[4:7], s63 offen sc1 lds
    s_mov_b32 m0, 76288
    s_add_u32 s63, s61, 8192
    buffer_load_dwordx4 v4, s[4:7], s63 offen sc1 lds
    s_mov_b32 m0, 77312
    s_add_u32 s63, s61, 9216
    buffer_load_dwordx4 v4, s[4:7], s63 offen sc1 lds
    s_mov_b32 m0, 78336
    s_add_u32 s63, s61, 10240
    buffer_load_dwordx4 v4, s[4:7], s63 offen sc1 lds
    s_mov_b32 m0, 79360
    s_add_u32 s63, s61, 11264
    buffer_load_dwordx4 v4, s[4:7], s63 offen sc1 lds
    s_mov_b32 m0, 80896
    s_add_u32 s63, s61, 12288
    buffer_load_dwordx4 v4, s[4:7], s63 offen sc1 lds
    s_mov_b32 m0, 81920
    s_add_u32 s63, s61, 13312
    buffer_load_dwordx4 v4, s[4:7], s63 offen sc1 lds
    s_mov_b32 m0, 82944
    s_add_u32 s63, s61, 14336
    buffer_load_dwordx4 v4, s[4:7], s63 offen sc1 lds
    s_mov_b32 m0, 83968
    s_add_u32 s63, s61, 15360
    buffer_load_dwordx4 v4, s[4:7], s63 offen sc1 lds
L_conv_nu:
    v_and_b32 v12, 15, v2
    v_lshrrev_b32 v13, 5, v2
    v_bfe_u32 v14, v2, 4, 1
    s_sub_u32 s62, s62, 448
    v_sub_u32 v15, v12, v13
    v_lshlrev_b32 v15, 5, v15
    v_lshl_add_u32 v15, v14, 4, v15
    v_add_u32 v6, s62, v15
    v_add_u32 v15, 1, v12
    v_and_b32 v3, 3, v15
    v_lshl_add_u32 v15, v13, 4, v12
    v_lshlrev_b32 v1, 3, v14
    v_sub_u32 v15, v15, v1
    v_sub_u32 v15, v15, v3
    v_add_u32 v15, 9, v15
    v_lshlrev_b32 v15, 1, v15
    v_mul_u32_u24 v3, 4160, v3
    s_mul_i32 s63, s26, 16640
    v_add3_u32 v7, v15, v3, s63
    v_add_u32 v1, 7, v1
    v_sub_u32 v1, v1, v12
    v_lshl_add_u32 v1, v13, 6, v1
    v_and_b32 v3, 1, v1
    v_lshlrev_b32 v3, 4, v3
    v_lshrrev_b32 v1, 1, v1
    s_waitcnt vmcnt(16)
    s_cmp_eq_u32 s26, 0
    s_cbranch_scc1 L_conv_d
    s_waitcnt vmcnt(0)
L_conv_d:
    v_lshlrev_b32 v5, v3, v5
    v_cmp_eq_u32 vcc, 0, v1
    s_nop 1
    v_cndmask_b32 v8, 0, v5, vcc
    v_cmp_eq_u32 vcc, 1, v1
    s_nop 1
    v_cndmask_b32 v9, 0, v5, vcc
    v_cmp_eq_u32 vcc, 2, v1
    s_nop 1
    v_cndmask_b32 v10, 0, v5, vcc
    v_cmp_eq_u32 vcc, 3, v1
    s_nop 1
    v_cndmask_b32 v11, 0, v5, vcc
    s_waitcnt vmcnt(0)
    s_barrier
    ds_read_b64 v[48:49], v7 offset:0
    ds_read_b64 v[50:51], v7 offset:8
    ds_read_b64 v[52:53], v7 offset:512
    ds_read_b64 v[54:55], v7 offset:520
    ds_read_b64 v[56:57], v7 offset:1024
    ds_read_b64 v[58:59], v7 offset:1032
    ds_read_b64 v[60:61], v7 offset:1536
    ds_read_b64 v[62:63], v7 offset:1544
    ds_read_b64 v[64:65], v7 offset:2048
    ds_read_b64 v[66:67], v7 offset:2056
    ds_read_b64 v[68:69], v7 offset:2560
    ds_read_b64 v[70:71], v7 offset:2568
    ds_read_b64 v[72:73], v7 offset:3072
    ds_read_b64 v[74:75], v7 offset:3080
    ds_read_b64 v[76:77], v7 offset:3584
    ds_read_b64 v[78:79], v7 offset:3592
    ds_read_b128 v[112:115], v6 offset:448
    ds_read_b128 v[116:119], v6 offset:960
    ds_read_b128 v[120:123], v6 offset:1472
    ds_read_b128 v[124:127], v6 offset:1984
    ds_read_b128 v[128:131], v6 offset:2496
    ds_read_b128 v[132:135], v6 offset:3008
    ds_read_b128 v[136:139], v6 offset:3520
    ds_read_b128 v[140:143], v6 offset:4032
    s_waitcnt lgkmcnt(0)
    v_mfma_f32_16x16x32_bf16 v[16:19], v[8:11], v[112:115], 0
    ds_read_b64 v[80:81], v7 offset:64
    v_mfma_f32_16x16x32_bf16 v[20:23], v[8:11], v[116:119], 0
    ds_read_b64 v[82:83], v7 offset:72
    v_mfma_f32_16x16x32_bf16 v[24:27], v[8:11], v[120:123], 0
    ds_read_b128 v[144:147], v6 offset:384
    v_mfma_f32_16x16x32_bf16 v[28:31], v[8:11], v[124:127], 0
    ds_read_b128 v[148:151], v6 offset:896
    v_mfma_f32_16x16x32_bf16 v[32:35], v[8:11], v[128:131], 0
    ds_read_b128 v[152:155], v6 offset:1408
    v_mfma_f32_16x16x32_bf16 v[36:39], v[8:11], v[132:135], 0
    ds_read_b128 v[156:159], v6 offset:1920
    v_mfma_f32_16x16x32_bf16 v[40:43], v[8:11], v[136:139], 0
    ds_read_b128 v[160:163], v6 offset:2432
    v_mfma_f32_16x16x32_bf16 v[44:47], v[8:11], v[140:143], 0
    ds_read_b128 v[164:167], v6 offset:2944
    v_mfma_f32_16x16x32_bf16 v[16:19], v[48:51], v[112:115], v[16:19]
    ds_read_b128 v[168:171], v6 offset:3456
    v_mfma_f32_16x16x32_bf16 v[20:23], v[48:51], v[116:119], v[20:23]
    ds_read_b128 v[172:175], v6 offset:3968
    v_mfma_f32_16x16x32_bf16 v[24:27], v[48:51], v[120:123], v[24:27]
    ds_read_b64 v[84:85], v7 offset:576
    v_mfma_f32_16x16x32_bf16 v[28:31], v[48:51], v[124:127], v[28:31]
    ds_read_b64 v[86:87], v7 offset:584
    v_mfma_f32_16x16x32_bf16 v[32:35], v[48:51], v[128:131], v[32:35]
    ds_read_b64 v[88:89], v7 offset:1088
    v_mfma_f32_16x16x32_bf16 v[36:39], v[48:51], v[132:135], v[36:39]
    ds_read_b64 v[90:91], v7 offset:1096
    v_mfma_f32_16x16x32_bf16 v[40:43], v[48:51], v[136:139], v[40:43]
    ds_read_b64 v[92:93], v7 offset:1600
    v_mfma_f32_16x16x32_bf16 v[44:47], v[48:51], v[140:143], v[44:47]
    ds_read_b64 v[94:95], v7 offset:1608
    v_mfma_f32_16x16x32_bf16 v[20:23], v[52:55], v[112:115], v[20:23]
    ds_read_b64 v[96:97], v7 offset:2112
    v_mfma_f32_16x16x32_bf16 v[24:27], v[52:55], v[116:119], v[24:27]
    ds_read_b64 v[98:99], v7 offset:2120
    v_mfma_f32_16x16x32_bf16 v[28:31], v[52:55], v[120:123], v[28:31]
    ds_read_b64 v[100:101], v7 offset:2624
    v_mfma_f32_16x16x32_bf16 v[32:35], v[52:55], v[124:127], v[32:35]
    ds_read_b64 v[102:103], v7 offset:2632
    v_mfma_f32_16x16x32_bf16 v[36:39], v[52:55], v[128:131], v[36:39]
    ds_read_b64 v[104:105], v7 offset:3136
    v_mfma_f32_16x16x32_bf16 v[40:43], v[52:55], v[132:135], v[40:43]
    ds_read_b64 v[106:107], v7 offset:3144
    v_mfma_f32_16x16x32_bf16 v[44:47], v[52:55], v[136:139], v[44:47]
    ds_read_b64 v[108:109], v7 offset:3648
    v_mfma_f32_16x16x32_bf16 v[24:27], v[56:59], v[112:115], v[24:27]
    ds_read_b64 v[110:111], v7 offset:3656
    v_mfma_f32_16x16x32_bf16 v[28:31], v[56:59], v[116:119], v[28:31]
    v_mfma_f32_16x16x32_bf16 v[32:35], v[56:59], v[120:123], v[32:35]
    v_mfma_f32_16x16x32_bf16 v[36:39], v[56:59], v[124:127], v[36:39]
    v_mfma_f32_16x16x32_bf16 v[40:43], v[56:59], v[128:131], v[40:43]
    v_mfma_f32_16x16x32_bf16 v[44:47], v[56:59], v[132:135], v[44:47]
    v_mfma_f32_16x16x32_bf16 v[28:31], v[60:63], v[112:115], v[28:31]
    v_mfma_f32_16x16x32_bf16 v[32:35], v[60:63], v[116:119], v[32:35]
    v_mfma_f32_16x16x32_bf16 v[36:39], v[60:63], v[120:123], v[36:39]
    v_mfma_f32_16x16x32_bf16 v[40:43], v[60:63], v[124:127], v[40:43]
    v_mfma_f32_16x16x32_bf16 v[44:47], v[60:63], v[128:131], v[44:47]
    v_mfma_f32_16x16x32_bf16 v[32:35], v[64:67], v[112:115], v[32:35]
    v_mfma_f32_16x16x32_bf16 v[36:39], v[64:67], v[116:119], v[36:39]
    v_mfma_f32_16x16x32_bf16 v[40:43], v[64:67], v[120:123], v[40:43]
    v_mfma_f32_16x16x32_bf16 v[44:47], v[64:67], v[124:127], v[44:47]
    v_mfma_f32_16x16x32_bf16 v[36:39], v[68:71], v[112:115], v[36:39]
    v_mfma_f32_16x16x32_bf16 v[40:43], v[68:71], v[116:119], v[40:43]
    v_mfma_f32_16x16x32_bf16 v[44:47], v[68:71], v[120:123], v[44:47]
    v_mfma_f32_16x16x32_bf16 v[40:43], v[72:75], v[112:115], v[40:43]
    v_mfma_f32_16x16x32_bf16 v[44:47], v[72:75], v[116:119], v[44:47]
    v_mfma_f32_16x16x32_bf16 v[44:47], v[76:79], v[112:115], v[44:47]
    s_waitcnt lgkmcnt(0)
    v_mfma_f32_16x16x32_bf16 v[16:19], v[80:83], v[144:147], v[16:19]
    ds_read_b64 v[48:49], v7 offset:128
    v_mfma_f32_16x16x32_bf16 v[20:23], v[80:83], v[148:151], v[20:23]
    ds_read_b64 v[50:51], v7 offset:136
    v_mfma_f32_16x16x32_bf16 v[24:27], v[80:83], v[152:155], v[24:27]
    ds_read_b128 v[112:115], v6 offset:320
    v_mfma_f32_16x16x32_bf16 v[28:31], v[80:83], v[156:159], v[28:31]
    ds_read_b128 v[116:119], v6 offset:832
    v_mfma_f32_16x16x32_bf16 v[32:35], v[80:83], v[160:163], v[32:35]
    ds_read_b128 v[120:123], v6 offset:1344
    v_mfma_f32_16x16x32_bf16 v[36:39], v[80:83], v[164:167], v[36:39]
    ds_read_b128 v[124:127], v6 offset:1856
    v_mfma_f32_16x16x32_bf16 v[40:43], v[80:83], v[168:171], v[40:43]
    ds_read_b128 v[128:131], v6 offset:2368
    v_mfma_f32_16x16x32_bf16 v[44:47], v[80:83], v[172:175], v[44:47]
    ds_read_b128 v[132:135], v6 offset:2880
    v_mfma_f32_16x16x32_bf16 v[20:23], v[84:87], v[144:147], v[20:23]
    ds_read_b128 v[136:139], v6 offset:3392
    v_mfma_f32_16x16x32_bf16 v[24:27], v[84:87], v[148:151], v[24:27]
    ds_read_b128 v[140:143], v6 offset:3904
    v_mfma_f32_16x16x32_bf16 v[28:31], v[84:87], v[152:155], v[28:31]
    ds_read_b64 v[52:53], v7 offset:640
    v_mfma_f32_16x16x32_bf16 v[32:35], v[84:87], v[156:159], v[32:35]
    ds_read_b64 v[54:55], v7 offset:648
    v_mfma_f32_16x16x32_bf16 v[36:39], v[84:87], v[160:163], v[36:39]
    ds_read_b64 v[56:57], v7 offset:1152
    v_mfma_f32_16x16x32_bf16 v[40:43], v[84:87], v[164:167], v[40:43]
    ds_read_b64 v[58:59], v7 offset:1160
    v_mfma_f32_16x16x32_bf16 v[44:47], v[84:87], v[168:171], v[44:47]
    ds_read_b64 v[60:61], v7 offset:1664
    v_mfma_f32_16x16x32_bf16 v[24:27], v[88:91], v[144:147], v[24:27]
    ds_read_b64 v[62:63], v7 offset:1672
    v_mfma_f32_16x16x32_bf16 v[28:31], v[88:91], v[148:151], v[28:31]
    ds_read_b64 v[64:65], v7 offset:2176
    v_mfma_f32_16x16x32_bf16 v[32:35], v[88:91], v[152:155], v[32:35]
    ds_read_b64 v[66:67], v7 offset:2184
    v_mfma_f32_16x16x32_bf16 v[36:39], v[88:91], v[156:159], v[36:39]
    ds_read_b64 v[68:69], v7 offset:2688
    v_mfma_f32_16x16x32_bf16 v[40:43], v[88:91], v[160:163], v[40:43]
    ds_read_b64 v[70:71], v7 offset:2696
    v_mfma_f32_16x16x32_bf16 v[44:47], v[88:91], v[164:167], v[44:47]
    ds_read_b64 v[72:73], v7 offset:3200
    v_mfma_f32_16x16x32_bf16 v[28:31], v[92:95], v[144:147], v[28:31]
    ds_read_b64 v[74:75], v7 offset:3208
    v_mfma_f32_16x16x32_bf16 v[32:35], v[92:95], v[148:151], v[32:35]
    ds_read_b64 v[76:77], v7 offset:3712
    v_mfma_f32_16x16x32_bf16 v[36:39], v[92:95], v[152:155], v[36:39]
    ds_read_b64 v[78:79], v7 offset:3720
    v_mfma_f32_16x16x32_bf16 v[40:43], v[92:95], v[156:159], v[40:43]
    v_mfma_f32_16x16x32_bf16 v[44:47], v[92:95], v[160:163], v[44:47]
    v_mfma_f32_16x16x32_bf16 v[32:35], v[96:99], v[144:147], v[32:35]
    v_mfma_f32_16x16x32_bf16 v[36:39], v[96:99], v[148:151], v[36:39]
    v_mfma_f32_16x16x32_bf16 v[40:43], v[96:99], v[152:155], v[40:43]
    v_mfma_f32_16x16x32_bf16 v[44:47], v[96:99], v[156:159], v[44:47]
    v_mfma_f32_16x16x32_bf16 v[36:39], v[100:103], v[144:147], v[36:39]
    v_mfma_f32_16x16x32_bf16 v[40:43], v[100:103], v[148:151], v[40:43]
    v_mfma_f32_16x16x32_bf16 v[44:47], v[100:103], v[152:155], v[44:47]
    v_mfma_f32_16x16x32_bf16 v[40:43], v[104:107], v[144:147], v[40:43]
    v_mfma_f32_16x16x32_bf16 v[44:47], v[104:107], v[148:151], v[44:47]
    v_mfma_f32_16x16x32_bf16 v[44:47], v[108:111], v[144:147], v[44:47]
    s_waitcnt lgkmcnt(0)
    v_mfma_f32_16x16x32_bf16 v[16:19], v[48:51], v[112:115], v[16:19]
    ds_read_b64 v[80:81], v7 offset:192
    v_mfma_f32_16x16x32_bf16 v[20:23], v[48:51], v[116:119], v[20:23]
    ds_read_b64 v[82:83], v7 offset:200
    v_mfma_f32_16x16x32_bf16 v[24:27], v[48:51], v[120:123], v[24:27]
    ds_read_b128 v[144:147], v6 offset:256
    v_mfma_f32_16x16x32_bf16 v[28:31], v[48:51], v[124:127], v[28:31]
    ds_read_b128 v[148:151], v6 offset:768
    v_mfma_f32_16x16x32_bf16 v[32:35], v[48:51], v[128:131], v[32:35]
    ds_read_b128 v[152:155], v6 offset:1280
    v_mfma_f32_16x16x32_bf16 v[36:39], v[48:51], v[132:135], v[36:39]
    ds_read_b128 v[156:159], v6 offset:1792
    v_mfma_f32_16x16x32_bf16 v[40:43], v[48:51], v[136:139], v[40:43]
    ds_read_b128 v[160:163], v6 offset:2304
    v_mfma_f32_16x16x32_bf16 v[44:47], v[48:51], v[140:143], v[44:47]
    ds_read_b128 v[164:167], v6 offset:2816
    v_mfma_f32_16x16x32_bf16 v[20:23], v[52:55], v[112:115], v[20:23]
    ds_read_b128 v[168:171], v6 offset:3328
    v_mfma_f32_16x16x32_bf16 v[24:27], v[52:55], v[116:119], v[24:27]
    ds_read_b128 v[172:175], v6 offset:3840
    v_mfma_f32_16x16x32_bf16 v[28:31], v[52:55], v[120:123], v[28:31]
    ds_read_b64 v[84:85], v7 offset:704
    v_mfma_f32_16x16x32_bf16 v[32:35], v[52:55], v[124:127], v[32:35]
    ds_read_b64 v[86:87], v7 offset:712
    v_mfma_f32_16x16x32_bf16 v[36:39], v[52:55], v[128:131], v[36:39]
    ds_read_b64 v[88:89], v7 offset:1216
    v_mfma_f32_16x16x32_bf16 v[40:43], v[52:55], v[132:135], v[40:43]
    ds_read_b64 v[90:91], v7 offset:1224
    v_mfma_f32_16x16x32_bf16 v[44:47], v[52:55], v[136:139], v[44:47]
    ds_read_b64 v[92:93], v7 offset:1728
    v_mfma_f32_16x16x32_bf16 v[24:27], v[56:59], v[112:115], v[24:27]
    ds_read_b64 v[94:95], v7 offset:1736
    v_mfma_f32_16x16x32_bf16 v[28:31], v[56:59], v[116:119], v[28:31]
    ds_read_b64 v[96:97], v7 offset:2240
    v_mfma_f32_16x16x32_bf16 v[32:35], v[56:59], v[120:123], v[32:35]
    ds_read_b64 v[98:99], v7 offset:2248
    v_mfma_f32_16x16x32_bf16 v[36:39], v[56:59], v[124:127], v[36:39]
    ds_read_b64 v[100:101], v7 offset:2752
    v_mfma_f32_16x16x32_bf16 v[40:43], v[56:59], v[128:131], v[40:43]
    ds_read_b64 v[102:103], v7 offset:2760
    v_mfma_f32_16x16x32_bf16 v[44:47], v[56:59], v[132:135], v[44:47]
    ds_read_b64 v[104:105], v7 offset:3264
    v_mfma_f32_16x16x32_bf16 v[28:31], v[60:63], v[112:115], v[28:31]
    ds_read_b64 v[106:107], v7 offset:3272
    v_mfma_f32_16x16x32_bf16 v[32:35], v[60:63], v[116:119], v[32:35]
    ds_read_b64 v[108:109], v7 offset:3776
    v_mfma_f32_16x16x32_bf16 v[36:39], v[60:63], v[120:123], v[36:39]
    ds_read_b64 v[110:111], v7 offset:3784
    v_mfma_f32_16x16x32_bf16 v[40:43], v[60:63], v[124:127], v[40:43]
    v_mfma_f32_16x16x32_bf16 v[44:47], v[60:63], v[128:131], v[44:47]
    v_mfma_f32_16x16x32_bf16 v[32:35], v[64:67], v[112:115], v[32:35]
    v_mfma_f32_16x16x32_bf16 v[36:39], v[64:67], v[116:119], v[36:39]
    v_mfma_f32_16x16x32_bf16 v[40:43], v[64:67], v[120:123], v[40:43]
    v_mfma_f32_16x16x32_bf16 v[44:47], v[64:67], v[124:127], v[44:47]
    v_mfma_f32_16x16x32_bf16 v[36:39], v[68:71], v[112:115], v[36:39]
    v_mfma_f32_16x16x32_bf16 v[40:43], v[68:71], v[116:119], v[40:43]
    v_mfma_f32_16x16x32_bf16 v[44:47], v[68:71], v[120:123], v[44:47]
    v_mfma_f32_16x16x32_bf16 v[40:43], v[72:75], v[112:115], v[40:43]
    v_mfma_f32_16x16x32_bf16 v[44:47], v[72:75], v[116:119], v[44:47]
    v_mfma_f32_16x16x32_bf16 v[44:47], v[76:79], v[112:115], v[44:47]
    s_waitcnt lgkmcnt(0)
    v_mfma_f32_16x16x32_bf16 v[16:19], v[80:83], v[144:147], v[16:19]
    ds_read_b64 v[48:49], v7 offset:256
    v_mfma_f32_16x16x32_bf16 v[20:23], v[80:83], v[148:151], v[20:23]
    ds_read_b64 v[50:51], v7 offset:264
    v_mfma_f32_16x16x32_bf16 v[24:27], v[80:83], v[152:155], v[24:27]
    ds_read_b128 v[112:115], v6 offset:192
    v_mfma_f32_16x16x32_bf16 v[28:31], v[80:83], v[156:159], v[28:31]
    ds_read_b128 v[116:119], v6 offset:704
    v_mfma_f32_16x16x32_bf16 v[32:35], v[80:83], v[160:163], v[32:35]
    ds_read_b128 v[120:123], v6 offset:1216
    v_mfma_f32_16x16x32_bf16 v[36:39], v[80:83], v[164:167], v[36:39]
    ds_read_b128 v[124:127], v6 offset:1728
    v_mfma_f32_16x16x32_bf16 v[40:43], v[80:83], v[168:171], v[40:43]
    ds_read_b128 v[128:131], v6 offset:2240
    v_mfma_f32_16x16x32_bf16 v[44:47], v[80:83], v[172:175], v[44:47]
    ds_read_b128 v[132:135], v6 offset:2752
    v_mfma_f32_16x16x32_bf16 v[20:23], v[84:87], v[144:147], v[20:23]
    ds_read_b128 v[136:139], v6 offset:3264
    v_mfma_f32_16x16x32_bf16 v[24:27], v[84:87], v[148:151], v[24:27]
    ds_read_b128 v[140:143], v6 offset:3776
    v_mfma_f32_16x16x32_bf16 v[28:31], v[84:87], v[152:155], v[28:31]
    ds_read_b64 v[52:53], v7 offset:768
    v_mfma_f32_16x16x32_bf16 v[32:35], v[84:87], v[156:159], v[32:35]
    ds_read_b64 v[54:55], v7 offset:776
    v_mfma_f32_16x16x32_bf16 v[36:39], v[84:87], v[160:163], v[36:39]
    ds_read_b64 v[56:57], v7 offset:1280
    v_mfma_f32_16x16x32_bf16 v[40:43], v[84:87], v[164:167], v[40:43]
    ds_read_b64 v[58:59], v7 offset:1288
    v_mfma_f32_16x16x32_bf16 v[44:47], v[84:87], v[168:171], v[44:47]
    ds_read_b64 v[60:61], v7 offset:1792
    v_mfma_f32_16x16x32_bf16 v[24:27], v[88:91], v[144:147], v[24:27]
    ds_read_b64 v[62:63], v7 offset:1800
    v_mfma_f32_16x16x32_bf16 v[28:31], v[88:91], v[148:151], v[28:31]
    ds_read_b64 v[64:65], v7 offset:2304
    v_mfma_f32_16x16x32_bf16 v[32:35], v[88:91], v[152:155], v[32:35]
    ds_read_b64 v[66:67], v7 offset:2312
    v_mfma_f32_16x16x32_bf16 v[36:39], v[88:91], v[156:159], v[36:39]
    ds_read_b64 v[68:69], v7 offset:2816
    v_mfma_f32_16x16x32_bf16 v[40:43], v[88:91], v[160:163], v[40:43]
    ds_read_b64 v[70:71], v7 offset:2824
    v_mfma_f32_16x16x32_bf16 v[44:47], v[88:91], v[164:167], v[44:47]
    ds_read_b64 v[72:73], v7 offset:3328
    v_mfma_f32_16x16x32_bf16 v[28:31], v[92:95], v[144:147], v[28:31]
    ds_read_b64 v[74:75], v7 offset:3336
    v_mfma_f32_16x16x32_bf16 v[32:35], v[92:95], v[148:151], v[32:35]
    ds_read_b64 v[76:77], v7 offset:3840
    v_mfma_f32_16x16x32_bf16 v[36:39], v[92:95], v[152:155], v[36:39]
    ds_read_b64 v[78:79], v7 offset:3848
    v_mfma_f32_16x16x32_bf16 v[40:43], v[92:95], v[156:159], v[40:43]
    v_mfma_f32_16x16x32_bf16 v[44:47], v[92:95], v[160:163], v[44:47]
    v_mfma_f32_16x16x32_bf16 v[32:35], v[96:99], v[144:147], v[32:35]
    v_mfma_f32_16x16x32_bf16 v[36:39], v[96:99], v[148:151], v[36:39]
    v_mfma_f32_16x16x32_bf16 v[40:43], v[96:99], v[152:155], v[40:43]
    v_mfma_f32_16x16x32_bf16 v[44:47], v[96:99], v[156:159], v[44:47]
    v_mfma_f32_16x16x32_bf16 v[36:39], v[100:103], v[144:147], v[36:39]
    v_mfma_f32_16x16x32_bf16 v[40:43], v[100:103], v[148:151], v[40:43]
    v_mfma_f32_16x16x32_bf16 v[44:47], v[100:103], v[152:155], v[44:47]
    v_mfma_f32_16x16x32_bf16 v[40:43], v[104:107], v[144:147], v[40:43]
    v_mfma_f32_16x16x32_bf16 v[44:47], v[104:107], v[148:151], v[44:47]
    v_mfma_f32_16x16x32_bf16 v[44:47], v[108:111], v[144:147], v[44:47]
    s_waitcnt lgkmcnt(0)
    v_mfma_f32_16x16x32_bf16 v[16:19], v[48:51], v[112:115], v[16:19]
    ds_read_b64 v[80:81], v7 offset:320
    v_mfma_f32_16x16x32_bf16 v[20:23], v[48:51], v[116:119], v[20:23]
    ds_read_b64 v[82:83], v7 offset:328
    v_mfma_f32_16x16x32_bf16 v[24:27], v[48:51], v[120:123], v[24:27]
    ds_read_b128 v[144:147], v6 offset:128
    v_mfma_f32_16x16x32_bf16 v[28:31], v[48:51], v[124:127], v[28:31]
    ds_read_b128 v[148:151], v6 offset:640
    v_mfma_f32_16x16x32_bf16 v[32:35], v[48:51], v[128:131], v[32:35]
    ds_read_b128 v[152:155], v6 offset:1152
    v_mfma_f32_16x16x32_bf16 v[36:39], v[48:51], v[132:135], v[36:39]
    ds_read_b128 v[156:159], v6 offset:1664
    v_mfma_f32_16x16x32_bf16 v[40:43], v[48:51], v[136:139], v[40:43]
    ds_read_b128 v[160:163], v6 offset:2176
    v_mfma_f32_16x16x32_bf16 v[44:47], v[48:51], v[140:143], v[44:47]
    ds_read_b128 v[164:167], v6 offset:2688
    v_mfma_f32_16x16x32_bf16 v[20:23], v[52:55], v[112:115], v[20:23]
    ds_read_b128 v[168:171], v6 offset:3200
    v_mfma_f32_16x16x32_bf16 v[24:27], v[52:55], v[116:119], v[24:27]
    ds_read_b128 v[172:175], v6 offset:3712
    v_mfma_f32_16x16x32_bf16 v[28:31], v[52:55], v[120:123], v[28:31]
    ds_read_b64 v[84:85], v7 offset:832
    v_mfma_f32_16x16x32_bf16 v[32:35], v[52:55], v[124:127], v[32:35]
    ds_read_b64 v[86:87], v7 offset:840
    v_mfma_f32_16x16x32_bf16 v[36:39], v[52:55], v[128:131], v[36:39]
    ds_read_b64 v[88:89], v7 offset:1344
    v_mfma_f32_16x16x32_bf16 v[40:43], v[52:55], v[132:135], v[40:43]
    ds_read_b64 v[90:91], v7 offset:1352
    v_mfma_f32_16x16x32_bf16 v[44:47], v[52:55], v[136:139], v[44:47]
    ds_read_b64 v[92:93], v7 offset:1856
    v_mfma_f32_16x16x32_bf16 v[24:27], v[56:59], v[112:115], v[24:27]
    ds_read_b64 v[94:95], v7 offset:1864
    v_mfma_f32_16x16x32_bf16 v[28:31], v[56:59], v[116:119], v[28:31]
    ds_read_b64 v[96:97], v7 offset:2368
    v_mfma_f32_16x16x32_bf16 v[32:35], v[56:59], v[120:123], v[32:35]
    ds_read_b64 v[98:99], v7 offset:2376
    v_mfma_f32_16x16x32_bf16 v[36:39], v[56:59], v[124:127], v[36:39]
    ds_read_b64 v[100:101], v7 offset:2880
    v_mfma_f32_16x16x32_bf16 v[40:43], v[56:59], v[128:131], v[40:43]
    ds_read_b64 v[102:103], v7 offset:2888
    v_mfma_f32_16x16x32_bf16 v[44:47], v[56:59], v[132:135], v[44:47]
    ds_read_b64 v[104:105], v7 offset:3392
    v_mfma_f32_16x16x32_bf16 v[28:31], v[60:63], v[112:115], v[28:31]
    ds_read_b64 v[106:107], v7 offset:3400
    v_mfma_f32_16x16x32_bf16 v[32:35], v[60:63], v[116:119], v[32:35]
    ds_read_b64 v[108:109], v7 offset:3904
    v_mfma_f32_16x16x32_bf16 v[36:39], v[60:63], v[120:123], v[36:39]
    ds_read_b64 v[110:111], v7 offset:3912
    v_mfma_f32_16x16x32_bf16 v[40:43], v[60:63], v[124:127], v[40:43]
    v_mfma_f32_16x16x32_bf16 v[44:47], v[60:63], v[128:131], v[44:47]
    v_mfma_f32_16x16x32_bf16 v[32:35], v[64:67], v[112:115], v[32:35]
    v_mfma_f32_16x16x32_bf16 v[36:39], v[64:67], v[116:119], v[36:39]
    v_mfma_f32_16x16x32_bf16 v[40:43], v[64:67], v[120:123], v[40:43]
    v_mfma_f32_16x16x32_bf16 v[44:47], v[64:67], v[124:127], v[44:47]
    v_mfma_f32_16x16x32_bf16 v[36:39], v[68:71], v[112:115], v[36:39]
    v_mfma_f32_16x16x32_bf16 v[40:43], v[68:71], v[116:119], v[40:43]
    v_mfma_f32_16x16x32_bf16 v[44:47], v[68:71], v[120:123], v[44:47]
    v_mfma_f32_16x16x32_bf16 v[40:43], v[72:75], v[112:115], v[40:43]
    v_mfma_f32_16x16x32_bf16 v[44:47], v[72:75], v[116:119], v[44:47]
    v_mfma_f32_16x16x32_bf16 v[44:47], v[76:79], v[112:115], v[44:47]
    s_waitcnt lgkmcnt(0)
    v_mfma_f32_16x16x32_bf16 v[16:19], v[80:83], v[144:147], v[16:19]
    ds_read_b64 v[48:49], v7 offset:384
    v_mfma_f32_16x16x32_bf16 v[20:23], v[80:83], v[148:151], v[20:23]
    ds_read_b64 v[50:51], v7 offset:392
    v_mfma_f32_16x16x32_bf16 v[24:27], v[80:83], v[152:155], v[24:27]
    ds_read_b128 v[112:115], v6 offset:64
    v_mfma_f32_16x16x32_bf16 v[28:31], v[80:83], v[156:159], v[28:31]
    ds_read_b128 v[116:119], v6 offset:576
    v_mfma_f32_16x16x32_bf16 v[32:35], v[80:83], v[160:163], v[32:35]
    ds_read_b128 v[120:123], v6 offset:1088
    v_mfma_f32_16x16x32_bf16 v[36:39], v[80:83], v[164:167], v[36:39]
    ds_read_b128 v[124:127], v6 offset:1600
    v_mfma_f32_16x16x32_bf16 v[40:43], v[80:83], v[168:171], v[40:43]
    ds_read_b128 v[128:131], v6 offset:2112
    v_mfma_f32_16x16x32_bf16 v[44:47], v[80:83], v[172:175], v[44:47]
    ds_read_b128 v[132:135], v6 offset:2624
    v_mfma_f32_16x16x32_bf16 v[20:23], v[84:87], v[144:147], v[20:23]
    ds_read_b128 v[136:139], v6 offset:3136
    v_mfma_f32_16x16x32_bf16 v[24:27], v[84:87], v[148:151], v[24:27]
    ds_read_b128 v[140:143], v6 offset:3648
    v_mfma_f32_16x16x32_bf16 v[28:31], v[84:87], v[152:155], v[28:31]
    ds_read_b64 v[52:53], v7 offset:896
    v_mfma_f32_16x16x32_bf16 v[32:35], v[84:87], v[156:159], v[32:35]
    ds_read_b64 v[54:55], v7 offset:904
    v_mfma_f32_16x16x32_bf16 v[36:39], v[84:87], v[160:163], v[36:39]
    ds_read_b64 v[56:57], v7 offset:1408
    v_mfma_f32_16x16x32_bf16 v[40:43], v[84:87], v[164:167], v[40:43]
    ds_read_b64 v[58:59], v7 offset:1416
    v_mfma_f32_16x16x32_bf16 v[44:47], v[84:87], v[168:171], v[44:47]
    ds_read_b64 v[60:61], v7 offset:1920
    v_mfma_f32_16x16x32_bf16 v[24:27], v[88:91], v[144:147], v[24:27]
    ds_read_b64 v[62:63], v7 offset:1928
    v_mfma_f32_16x16x32_bf16 v[28:31], v[88:91], v[148:151], v[28:31]
    ds_read_b64 v[64:65], v7 offset:2432
    v_mfma_f32_16x16x32_bf16 v[32:35], v[88:91], v[152:155], v[32:35]
    ds_read_b64 v[66:67], v7 offset:2440
    v_mfma_f32_16x16x32_bf16 v[36:39], v[88:91], v[156:159], v[36:39]
    ds_read_b64 v[68:69], v7 offset:2944
    v_mfma_f32_16x16x32_bf16 v[40:43], v[88:91], v[160:163], v[40:43]
    ds_read_b64 v[70:71], v7 offset:2952
    v_mfma_f32_16x16x32_bf16 v[44:47], v[88:91], v[164:167], v[44:47]
    ds_read_b64 v[72:73], v7 offset:3456
    v_mfma_f32_16x16x32_bf16 v[28:31], v[92:95], v[144:147], v[28:31]
    ds_read_b64 v[74:75], v7 offset:3464
    v_mfma_f32_16x16x32_bf16 v[32:35], v[92:95], v[148:151], v[32:35]
    ds_read_b64 v[76:77], v7 offset:3968
    v_mfma_f32_16x16x32_bf16 v[36:39], v[92:95], v[152:155], v[36:39]
    ds_read_b64 v[78:79], v7 offset:3976
    v_mfma_f32_16x16x32_bf16 v[40:43], v[92:95], v[156:159], v[40:43]
    v_mfma_f32_16x16x32_bf16 v[44:47], v[92:95], v[160:163], v[44:47]
    v_mfma_f32_16x16x32_bf16 v[32:35], v[96:99], v[144:147], v[32:35]
    v_mfma_f32_16x16x32_bf16 v[36:39], v[96:99], v[148:151], v[36:39]
    v_mfma_f32_16x16x32_bf16 v[40:43], v[96:99], v[152:155], v[40:43]
    v_mfma_f32_16x16x32_bf16 v[44:47], v[96:99], v[156:159], v[44:47]
    v_mfma_f32_16x16x32_bf16 v[36:39], v[100:103], v[144:147], v[36:39]
    v_mfma_f32_16x16x32_bf16 v[40:43], v[100:103], v[148:151], v[40:43]
    v_mfma_f32_16x16x32_bf16 v[44:47], v[100:103], v[152:155], v[44:47]
    v_mfma_f32_16x16x32_bf16 v[40:43], v[104:107], v[144:147], v[40:43]
    v_mfma_f32_16x16x32_bf16 v[44:47], v[104:107], v[148:151], v[44:47]
    v_mfma_f32_16x16x32_bf16 v[44:47], v[108:111], v[144:147], v[44:47]
    s_waitcnt lgkmcnt(0)
    v_mfma_f32_16x16x32_bf16 v[16:19], v[48:51], v[112:115], v[16:19]
    ds_read_b64 v[80:81], v7 offset:448
    v_mfma_f32_16x16x32_bf16 v[20:23], v[48:51], v[116:119], v[20:23]
    ds_read_b64 v[82:83], v7 offset:456
    v_mfma_f32_16x16x32_bf16 v[24:27], v[48:51], v[120:123], v[24:27]
    ds_read_b128 v[144:147], v6 offset:0
    v_mfma_f32_16x16x32_bf16 v[28:31], v[48:51], v[124:127], v[28:31]
    ds_read_b128 v[148:151], v6 offset:512
    v_mfma_f32_16x16x32_bf16 v[32:35], v[48:51], v[128:131], v[32:35]
    ds_read_b128 v[152:155], v6 offset:1024
    v_mfma_f32_16x16x32_bf16 v[36:39], v[48:51], v[132:135], v[36:39]
    ds_read_b128 v[156:159], v6 offset:1536
    v_mfma_f32_16x16x32_bf16 v[40:43], v[48:51], v[136:139], v[40:43]
    ds_read_b128 v[160:163], v6 offset:2048
    v_mfma_f32_16x16x32_bf16 v[44:47], v[48:51], v[140:143], v[44:47]
    ds_read_b128 v[164:167], v6 offset:2560
    v_mfma_f32_16x16x32_bf16 v[20:23], v[52:55], v[112:115], v[20:23]
    ds_read_b128 v[168:171], v6 offset:3072
    v_mfma_f32_16x16x32_bf16 v[24:27], v[52:55], v[116:119], v[24:27]
    ds_read_b128 v[172:175], v6 offset:3584
    v_mfma_f32_16x16x32_bf16 v[28:31], v[52:55], v[120:123], v[28:31]
    ds_read_b64 v[84:85], v7 offset:960
    v_mfma_f32_16x16x32_bf16 v[32:35], v[52:55], v[124:127], v[32:35]
    ds_read_b64 v[86:87], v7 offset:968
    v_mfma_f32_16x16x32_bf16 v[36:39], v[52:55], v[128:131], v[36:39]
    ds_read_b64 v[88:89], v7 offset:1472
    v_mfma_f32_16x16x32_bf16 v[40:43], v[52:55], v[132:135], v[40:43]
    ds_read_b64 v[90:91], v7 offset:1480
    v_mfma_f32_16x16x32_bf16 v[44:47], v[52:55], v[136:139], v[44:47]
    ds_read_b64 v[92:93], v7 offset:1984
    v_mfma_f32_16x16x32_bf16 v[24:27], v[56:59], v[112:115], v[24:27]
    ds_read_b64 v[94:95], v7 offset:1992
    v_mfma_f32_16x16x32_bf16 v[28:31], v[56:59], v[116:119], v[28:31]
    ds_read_b64 v[96:97], v7 offset:2496
    v_mfma_f32_16x16x32_bf16 v[32:35], v[56:59], v[120:123], v[32:35]
    ds_read_b64 v[98:99], v7 offset:2504
    v_mfma_f32_16x16x32_bf16 v[36:39], v[56:59], v[124:127], v[36:39]
    ds_read_b64 v[100:101], v7 offset:3008
    v_mfma_f32_16x16x32_bf16 v[40:43], v[56:59], v[128:131], v[40:43]
    ds_read_b64 v[102:103], v7 offset:3016
    v_mfma_f32_16x16x32_bf16 v[44:47], v[56:59], v[132:135], v[44:47]
    ds_read_b64 v[104:105], v7 offset:3520
    v_mfma_f32_16x16x32_bf16 v[28:31], v[60:63], v[112:115], v[28:31]
    ds_read_b64 v[106:107], v7 offset:3528
    v_mfma_f32_16x16x32_bf16 v[32:35], v[60:63], v[116:119], v[32:35]
    ds_read_b64 v[108:109], v7 offset:4032
    v_mfma_f32_16x16x32_bf16 v[36:39], v[60:63], v[120:123], v[36:39]
    ds_read_b64 v[110:111], v7 offset:4040
    v_mfma_f32_16x16x32_bf16 v[40:43], v[60:63], v[124:127], v[40:43]
    v_mfma_f32_16x16x32_bf16 v[44:47], v[60:63], v[128:131], v[44:47]
    v_mfma_f32_16x16x32_bf16 v[32:35], v[64:67], v[112:115], v[32:35]
    v_mfma_f32_16x16x32_bf16 v[36:39], v[64:67], v[116:119], v[36:39]
    v_mfma_f32_16x16x32_bf16 v[40:43], v[64:67], v[120:123], v[40:43]
    v_mfma_f32_16x16x32_bf16 v[44:47], v[64:67], v[124:127], v[44:47]
    v_mfma_f32_16x16x32_bf16 v[36:39], v[68:71], v[112:115], v[36:39]
    v_mfma_f32_16x16x32_bf16 v[40:43], v[68:71], v[116:119], v[40:43]
    v_mfma_f32_16x16x32_bf16 v[44:47], v[68:71], v[120:123], v[44:47]
    v_mfma_f32_16x16x32_bf16 v[40:43], v[72:75], v[112:115], v[40:43]
    v_mfma_f32_16x16x32_bf16 v[44:47], v[72:75], v[116:119], v[44:47]
    v_mfma_f32_16x16x32_bf16 v[44:47], v[76:79], v[112:115], v[44:47]
    s_waitcnt lgkmcnt(0)
    v_mfma_f32_16x16x32_bf16 v[16:19], v[80:83], v[144:147], v[16:19]
    v_mfma_f32_16x16x32_bf16 v[20:23], v[80:83], v[148:151], v[20:23]
    v_mfma_f32_16x16x32_bf16 v[24:27], v[80:83], v[152:155], v[24:27]
    v_mfma_f32_16x16x32_bf16 v[28:31], v[80:83], v[156:159], v[28:31]
    v_mfma_f32_16x16x32_bf16 v[32:35], v[80:83], v[160:163], v[32:35]
    v_mfma_f32_16x16x32_bf16 v[36:39], v[80:83], v[164:167], v[36:39]
    v_mfma_f32_16x16x32_bf16 v[40:43], v[80:83], v[168:171], v[40:43]
    v_mfma_f32_16x16x32_bf16 v[44:47], v[80:83], v[172:175], v[44:47]
    v_mfma_f32_16x16x32_bf16 v[20:23], v[84:87], v[144:147], v[20:23]
    v_mfma_f32_16x16x32_bf16 v[24:27], v[84:87], v[148:151], v[24:27]
    v_mfma_f32_16x16x32_bf16 v[28:31], v[84:87], v[152:155], v[28:31]
    v_mfma_f32_16x16x32_bf16 v[32:35], v[84:87], v[156:159], v[32:35]
    v_mfma_f32_16x16x32_bf16 v[36:39], v[84:87], v[160:163], v[36:39]
    v_mfma_f32_16x16x32_bf16 v[40:43], v[84:87], v[164:167], v[40:43]
    v_mfma_f32_16x16x32_bf16 v[44:47], v[84:87], v[168:171], v[44:47]
    v_mfma_f32_16x16x32_bf16 v[24:27], v[88:91], v[144:147], v[24:27]
    v_mfma_f32_16x16x32_bf16 v[28:31], v[88:91], v[148:151], v[28:31]
    v_mfma_f32_16x16x32_bf16 v[32:35], v[88:91], v[152:155], v[32:35]
    v_mfma_f32_16x16x32_bf16 v[36:39], v[88:91], v[156:159], v[36:39]
    v_mfma_f32_16x16x32_bf16 v[40:43], v[88:91], v[160:163], v[40:43]
    v_mfma_f32_16x16x32_bf16 v[44:47], v[88:91], v[164:167], v[44:47]
    v_mfma_f32_16x16x32_bf16 v[28:31], v[92:95], v[144:147], v[28:31]
    v_mfma_f32_16x16x32_bf16 v[32:35], v[92:95], v[148:151], v[32:35]
    v_mfma_f32_16x16x32_bf16 v[36:39], v[92:95], v[152:155], v[36:39]
    v_mfma_f32_16x16x32_bf16 v[40:43], v[92:95], v[156:159], v[40:43]
    v_mfma_f32_16x16x32_bf16 v[44:47], v[92:95], v[160:163], v[44:47]
    v_mfma_f32_16x16x32_bf16 v[32:35], v[96:99], v[144:147], v[32:35]
    v_mfma_f32_16x16x32_bf16 v[36:39], v[96:99], v[148:151], v[36:39]
    v_mfma_f32_16x16x32_bf16 v[40:43], v[96:99], v[152:155], v[40:43]
    v_mfma_f32_16x16x32_bf16 v[44:47], v[96:99], v[156:159], v[44:47]
    v_mfma_f32_16x16x32_bf16 v[36:39], v[100:103], v[144:147], v[36:39]
    v_mfma_f32_16x16x32_bf16 v[40:43], v[100:103], v[148:151], v[40:43]
    v_mfma_f32_16x16x32_bf16 v[44:47], v[100:103], v[152:155], v[44:47]
    v_mfma_f32_16x16x32_bf16 v[40:43], v[104:107], v[144:147], v[40:43]
    v_mfma_f32_16x16x32_bf16 v[44:47], v[104:107], v[148:151], v[44:47]
    v_mfma_f32_16x16x32_bf16 v[44:47], v[108:111], v[144:147], v[44:47]
    v_lshlrev_b32 v12, 5, v12
    v_lshrrev_b32 v13, 4, v2
    v_lshl_add_u32 v12, v13, 3, v12
    s_mul_i32 s63, s26, 16672
    v_add_u32 v12, s63, v12
    v_cvt_pk_bf16_f32 v48, v16, v17
    v_cvt_pk_bf16_f32 v49, v18, v19
    ds_write_b64 v12, v[48:49] offset:0
    v_cvt_pk_bf16_f32 v50, v20, v21
    v_cvt_pk_bf16_f32 v51, v22, v23
    ds_write_b64 v12, v[50:51] offset:512
    v_cvt_pk_bf16_f32 v52, v24, v25
    v_cvt_pk_bf16_f32 v53, v26, v27
    ds_write_b64 v12, v[52:53] offset:1024
    v_cvt_pk_bf16_f32 v54, v28, v29
    v_cvt_pk_bf16_f32 v55, v30, v31
    ds_write_b64 v12, v[54:55] offset:1536
    v_cvt_pk_bf16_f32 v56, v32, v33
    v_cvt_pk_bf16_f32 v57, v34, v35
    ds_write_b64 v12, v[56:57] offset:2048
    v_cvt_pk_bf16_f32 v58, v36, v37
    v_cvt_pk_bf16_f32 v59, v38, v39
    ds_write_b64 v12, v[58:59] offset:2560
    v_cvt_pk_bf16_f32 v60, v40, v41
    v_cvt_pk_bf16_f32 v61, v42, v43
    ds_write_b64 v12, v[60:61] offset:3072
    v_cvt_pk_bf16_f32 v62, v44, v45
    v_cvt_pk_bf16_f32 v63, v46, v47
    ds_write_b64 v12, v[62:63] offset:3584
    s_waitcnt lgkmcnt(0)
    s_barrier
    s_branch L_qkv_pre
L_conv_help:
    s_lshr_b32 s60, s25, 4
    v_min_u32 v5, 35, v2
    v_lshl_add_u32 v5, v5, 1, s60
    v_lshlrev_b32 v5, 6, v5
    s_mov_b32 s62, 20480
    v_and_b32 v4, 31, v2
    v_lshlrev_b32 v4, 6, v4
    s_lshl_b32 s63, s67, 11
    s_add_u32 s63, s63, 442368
    v_lshlrev_b32 v3, 3, v2
    s_lshl_b32 s60, s67, 12
    s_add_u32 s60, s60, 720896
    v_and_b32 v14, 31, v2
    v_lshrrev_b32 v15, 5, v2
    v_mul_u32_u24 v15, 36864, v15
    v_lshl_add_u32 v14, v14, 3, v15
    s_mul_i32 s76, s67, 589824
    s_lshl_b32 s61, s66, 8
    s_add_u32 s76, s76, s61
    s_add_u32 s61, s76, 33554432
    s_mov_b32 s96, 400000
    s_mov_b64 exec, 1
Lp1_7:
    buffer_load_dwordx2 v[6:7], v4, s[4:7], s63 offen offset:0 sc1
    s_waitcnt vmcnt(0)
    v_cmp_eq_u64 vcc, s[28:29], v[6:7]
    s_nop 0
    s_cmp_lg_u64 vcc, 0
    s_cbranch_scc1 Lp1d_8
    s_sleep 4
    s_sub_u32 s96, s96, 1
    s_cmp_gt_u32 s96, 1
    s_cbranch_scc1 Lp1_7
Lp1d_8:
    s_mov_b64 exec, -1
Lpoll_5:
    buffer_load_dwordx2 v[6:7], v4, s[4:7], s63 offen offset:0 sc1
    s_waitcnt vmcnt(0)
    v_cmp_ne_u64 vcc, s[28:29], v[6:7]
    s_nop 0
    s_cmp_eq_u64 vcc, 0
    s_cbranch_scc1 Lpolld_6
    s_mov_b64 exec, vcc
    s_sleep 1
    s_sub_u32 s96, s96, 1
    s_cmp_lg_u32 s96, 0
    s_cbranch_scc1 Lpoll_5
    v_mov_b32 v6, 2
    v_mov_b32 v7, 0
    global_store_dword v7, v6, s[52:53]
    s_waitcnt vmcnt(0)
Lpolld_6:
    s_mov_b64 exec, -1
    buffer_load_dwordx2 v[32:33], v3, s[4:7], s60 offen offset:0 sc1
    buffer_load_dwordx2 v[16:17], v14, s[4:7], s61 offen sc1
    s_add_u32 s61, s61, 73728
    buffer_load_dwordx2 v[34:35], v3, s[4:7], s60 offen offset:512 sc1
    buffer_load_dwordx2 v[18:19], v14, s[4:7], s61 offen sc1
    s_add_u32 s61, s61, 73728
    buffer_load_dwordx2 v[36:37], v3, s[4:7], s60 offen offset:1024 sc1
    buffer_load_dwordx2 v[20:21], v14, s[4:7], s61 offen sc1
    s_add_u32 s61, s61, 73728
    buffer_load_dwordx2 v[38:39], v3, s[4:7], s60 offen offset:1536 sc1
    buffer_load_dwordx2 v[22:23], v14, s[4:7], s61 offen sc1
    s_add_u32 s61, s61, 73728
    buffer_load_dwordx2 v[40:41], v3, s[4:7], s60 offen offset:2048 sc1
    buffer_load_dwordx2 v[24:25], v14, s[4:7], s61 offen sc1
    s_add_u32 s61, s61, 73728
    buffer_load_dwordx2 v[42:43], v3, s[4:7], s60 offen offset:2560 sc1
    buffer_load_dwordx2 v[26:27], v14, s[4:7], s61 offen sc1
    s_add_u32 s61, s61, 73728
    buffer_load_dwordx2 v[44:45], v3, s[4:7], s60 offen offset:3072 sc1
    buffer_load_dwordx2 v[28:29], v14, s[4:7], s61 offen sc1
    s_add_u32 s61, s61, 73728
    buffer_load_dwordx2 v[46:47], v3, s[4:7], s60 offen offset:3584 sc1
    buffer_load_dwordx2 v[30:31], v14, s[4:7], s61 offen sc1
    v_mov_b32 v13, v5
    s_waitcnt vmcnt(0)
    v_bfe_u32 v4, v2, 2, 2
    v_mul_u32_u24 v4, 16672, v4
    v_lshrrev_b32 v5, 4, v2
    v_lshl_add_u32 v4, v5, 5, v4
    v_and_b32 v5, 3, v2
    v_lshl_add_u32 v4, v5, 3, v4
    s_lshl_b32 s60, s67, 10
    v_add_u32 v4, s60, v4
    s_mov_b32 s64, 0xffff0000
    s_add_u32 s61, s76, 11534336
    s_add_u32 s60, s76, 8388608
    v_lshlrev_b32 v64, 16, v16
    v_and_b32 v65, s64, v16
    v_lshlrev_b32 v66, 16, v17
    v_and_b32 v67, s64, v17
    v_fma_f32 v68, v64, v32, v33
    v_fma_f32 v69, v65, v32, v33
    v_fma_f32 v70, v66, v32, v33
    v_fma_f32 v71, v67, v32, v33
    v_lshlrev_b32 v72, 16, v18
    v_and_b32 v73, s64, v18
    v_lshlrev_b32 v74, 16, v19
    v_and_b32 v75, s64, v19
    v_fma_f32 v76, v72, v34, v35
    v_fma_f32 v77, v73, v34, v35
    v_fma_f32 v78, v74, v34, v35
    v_fma_f32 v79, v75, v34, v35
    v_lshlrev_b32 v80, 16, v20
    v_and_b32 v81, s64, v20
    v_lshlrev_b32 v82, 16, v21
    v_and_b32 v83, s64, v21
    v_fma_f32 v84, v80, v36, v37
    v_fma_f32 v85, v81, v36, v37
    v_fma_f32 v86, v82, v36, v37
    v_fma_f32 v87, v83, v36, v37
    v_lshlrev_b32 v88, 16, v22
    v_and_b32 v89, s64, v22
    v_lshlrev_b32 v90, 16, v23
    v_and_b32 v91, s64, v23
    v_fma_f32 v92, v88, v38, v39
    v_fma_f32 v93, v89, v38, v39
    v_fma_f32 v94, v90, v38, v39
    v_fma_f32 v95, v91, v38, v39
    v_lshlrev_b32 v96, 16, v24
    v_and_b32 v97, s64, v24
    v_lshlrev_b32 v98, 16, v25
    v_and_b32 v99, s64, v25
    v_fma_f32 v100, v96, v40, v41
    v_fma_f32 v101, v97, v40, v41
    v_fma_f32 v102, v98, v40, v41
    v_fma_f32 v103, v99, v40, v41
    v_lshlrev_b32 v104, 16, v26
    v_and_b32 v105, s64, v26
    v_lshlrev_b32 v106, 16, v27
    v_and_b32 v107, s64, v27
    v_fma_f32 v108, v104, v42, v43
    v_fma_f32 v109, v105, v42, v43
    v_fma_f32 v110, v106, v42, v43
    v_fma_f32 v111, v107, v42, v43
    v_lshlrev_b32 v112, 16, v28
    v_and_b32 v113, s64, v28
    v_lshlrev_b32 v114, 16, v29
    v_and_b32 v115, s64, v29
    v_fma_f32 v116, v112, v44, v45
    v_fma_f32 v117, v113, v44, v45
    v_fma_f32 v118, v114, v44, v45
    v_fma_f32 v119, v115, v44, v45
    v_lshlrev_b32 v120, 16, v30
    v_and_b32 v121, s64, v30
    v_lshlrev_b32 v122, 16, v31
    v_and_b32 v123, s64, v31
    v_fma_f32 v124, v120, v46, v47
    v_fma_f32 v125, v121, v46, v47
    v_fma_f32 v126, v122, v46, v47
    v_fma_f32 v127, v123, v46, v47
    buffer_load_dwordx2 v[128:129], v13, s[4:7], s62 offen sc1
    s_mov_b32 s77, 0
    s_barrier
    ds_read_b64_tr_b16 v[232:233], v4 offset:0
    ds_read_b64_tr_b16 v[234:235], v4 offset:128
    ds_read_b64_tr_b16 v[236:237], v4 offset:256
    ds_read_b64_tr_b16 v[238:239], v4 offset:384
    ds_read_b64_tr_b16 v[240:241], v4 offset:512
    ds_read_b64_tr_b16 v[242:243], v4 offset:640
    ds_read_b64_tr_b16 v[244:245], v4 offset:768
    ds_read_b64_tr_b16 v[246:247], v4 offset:896
    s_waitcnt lgkmcnt(7)
    v_lshlrev_b32 v8, 16, v232
    v_and_b32 v9, s64, v232
    v_fmac_f32 v64, v68, v8
    v_fmac_f32 v65, v69, v9
    v_lshlrev_b32 v8, 16, v233
    v_and_b32 v9, s64, v233
    v_fmac_f32 v66, v70, v8
    v_fmac_f32 v67, v71, v9
    v_cvt_pk_bf16_f32 v16, v64, v65
    v_cvt_pk_bf16_f32 v17, v66, v67
    buffer_store_dwordx2 v[16:17], v14, s[4:7], s60 offen sc1
    s_add_u32 s60, s60, 73728
    s_waitcnt lgkmcnt(6)
    v_lshlrev_b32 v8, 16, v234
    v_and_b32 v9, s64, v234
    v_fmac_f32 v72, v76, v8
    v_fmac_f32 v73, v77, v9
    v_lshlrev_b32 v8, 16, v235
    v_and_b32 v9, s64, v235
    v_fmac_f32 v74, v78, v8
    v_fmac_f32 v75, v79, v9
    v_cvt_pk_bf16_f32 v18, v72, v73
    v_cvt_pk_bf16_f32 v19, v74, v75
    buffer_store_dwordx2 v[18:19], v14, s[4:7], s60 offen sc1
    s_add_u32 s60, s60, 73728
    s_waitcnt lgkmcnt(5)
    v_lshlrev_b32 v8, 16, v236
    v_and_b32 v9, s64, v236
    v_fmac_f32 v80, v84, v8
    v_fmac_f32 v81, v85, v9
    v_lshlrev_b32 v8, 16, v237
    v_and_b32 v9, s64, v237
    v_fmac_f32 v82, v86, v8
    v_fmac_f32 v83, v87, v9
    v_cvt_pk_bf16_f32 v20, v80, v81
    v_cvt_pk_bf16_f32 v21, v82, v83
    buffer_store_dwordx2 v[20:21], v14, s[4:7], s60 offen sc1
    s_add_u32 s60, s60, 73728
    s_waitcnt lgkmcnt(4)
    v_lshlrev_b32 v8, 16, v238
    v_and_b32 v9, s64, v238
    v_fmac_f32 v88, v92, v8
    v_fmac_f32 v89, v93, v9
    v_lshlrev_b32 v8, 16, v239
    v_and_b32 v9, s64, v239
    v_fmac_f32 v90, v94, v8
    v_fmac_f32 v91, v95, v9
    v_cvt_pk_bf16_f32 v22, v88, v89
    v_cvt_pk_bf16_f32 v23, v90, v91
    buffer_store_dwordx2 v[22:23], v14, s[4:7], s60 offen sc1
    s_add_u32 s60, s60, 73728
    s_waitcnt lgkmcnt(3)
    v_lshlrev_b32 v8, 16, v240
    v_and_b32 v9, s64, v240
    v_fmac_f32 v96, v100, v8
    v_fmac_f32 v97, v101, v9
    v_lshlrev_b32 v8, 16, v241
    v_and_b32 v9, s64, v241
    v_fmac_f32 v98, v102, v8
    v_fmac_f32 v99, v103, v9
    v_cvt_pk_bf16_f32 v24, v96, v97
    v_cvt_pk_bf16_f32 v25, v98, v99
    buffer_store_dwordx2 v[24:25], v14, s[4:7], s60 offen sc1
    s_add_u32 s60, s60, 73728
    s_waitcnt lgkmcnt(2)
    v_lshlrev_b32 v8, 16, v242
    v_and_b32 v9, s64, v242
    v_fmac_f32 v104, v108, v8
    v_fmac_f32 v105, v109, v9
    v_lshlrev_b32 v8, 16, v243
    v_and_b32 v9, s64, v243
    v_fmac_f32 v106, v110, v8
    v_fmac_f32 v107, v111, v9
    v_cvt_pk_bf16_f32 v26, v104, v105
    v_cvt_pk_bf16_f32 v27, v106, v107
    buffer_store_dwordx2 v[26:27], v14, s[4:7], s60 offen sc1
    s_add_u32 s60, s60, 73728
    s_waitcnt lgkmcnt(1)
    v_lshlrev_b32 v8, 16, v244
    v_and_b32 v9, s64, v244
    v_fmac_f32 v112, v116, v8
    v_fmac_f32 v113, v117, v9
    v_lshlrev_b32 v8, 16, v245
    v_and_b32 v9, s64, v245
    v_fmac_f32 v114, v118, v8
    v_fmac_f32 v115, v119, v9
    v_cvt_pk_bf16_f32 v28, v112, v113
    v_cvt_pk_bf16_f32 v29, v114, v115
    buffer_store_dwordx2 v[28:29], v14, s[4:7], s60 offen sc1
    s_add_u32 s60, s60, 73728
    s_waitcnt lgkmcnt(0)
    v_lshlrev_b32 v8, 16, v246
    v_and_b32 v9, s64, v246
    v_fmac_f32 v120, v124, v8
    v_fmac_f32 v121, v125, v9
    v_lshlrev_b32 v8, 16, v247
    v_and_b32 v9, s64, v247
    v_fmac_f32 v122, v126, v8
    v_fmac_f32 v123, v127, v9
    v_cvt_pk_bf16_f32 v30, v120, v121
    v_cvt_pk_bf16_f32 v31, v122, v123
    buffer_store_dwordx2 v[30:31], v14, s[4:7], s60 offen sc1
    s_add_u32 s60, s60, 73728
    s_lshl_b32 s60, s66, 2
    s_add_u32 s60, s60, s67
    s_lshl_b32 s60, s60, 6
    s_add_u32 s60, s60, 32768
    s_waitcnt vmcnt(0)
    v_mov_b32 v10, s28
    v_mov_b32 v11, s29
    v_mov_b32 v12, 0
    s_mov_b64 exec, 1
    buffer_store_dwordx2 v[10:11], v12, s[4:7], s60 offen sc1
    s_mov_b64 exec, -1
    v_mov_b32 v248, v14
    s_mov_b32 s79, s61
    s_add_u32 s80, s60, 1081344
    v_cmp_ne_u64 vcc, s[28:29], v[128:129]
    s_nop 0
    s_cmp_eq_u64 vcc, 0
    s_cbranch_scc1 L_9
    s_mov_b32 s96, 400000
Lpoll_10:
    buffer_load_dwordx2 v[128:129], v13, s[4:7], s62 offen offset:0 sc1
    s_waitcnt vmcnt(0)
    v_cmp_ne_u64 vcc, s[28:29], v[128:129]
    s_nop 0
    s_cmp_eq_u64 vcc, 0
    s_cbranch_scc1 Lpolld_11
    s_mov_b64 exec, vcc
    s_sleep 1
    s_sub_u32 s96, s96, 1
    s_cmp_lg_u32 s96, 0
    s_cbranch_scc1 Lpoll_10
    v_mov_b32 v128, 3
    v_mov_b32 v129, 0
    global_store_dword v129, v128, s[52:53]
    s_waitcnt vmcnt(0)
Lpolld_11:
    s_mov_b64 exec, -1
L_9:
    s_mul_i32 s60, s25, 64512
    s_add_u32 s60, s60, 5242880
    s_sub_u32 s62, s26, 4
    s_add_u32 s62, s62, s77
    v_lshlrev_b32 v4, 4, v2
L_12:
    s_lshl_b32 s63, s62, 10
    s_add_u32 m0, s63, 99328
    s_add_u32 s63, s63, s60
    s_add_u32 s62, s62, 4
    buffer_load_dwordx4 v4, s[4:7], s63 offen sc1  lds
    s_cmp_lt_u32 s62, 63
    s_cbranch_scc1 L_12
    s_cmp_eq_u32 s26, 7
    s_cbranch_scc1 L_help_c0
    s_waitcnt vmcnt(0)
    s_branch L_qkv_pre
L_help_c0:
    s_mul_i32 s60, s25, 9216
    s_add_u32 s60, s60, 1835008
    v_lshlrev_b32 v4, 4, v2
    buffer_load_dwordx4 v[168:171], v4, s[4:7], s60 offen sc1
    s_add_u32 s60, s60, 1024
    buffer_load_dwordx4 v[172:175], v4, s[4:7], s60 offen sc1
    s_add_u32 s60, s60, 1024
    buffer_load_dwordx4 v[176:179], v4, s[4:7], s60 offen sc1
    s_add_u32 s60, s60, 1024
    buffer_load_dwordx4 v[180:183], v4, s[4:7], s60 offen sc1
    s_add_u32 s60, s60, 1024
    buffer_load_dwordx4 v[184:187], v4, s[4:7], s60 offen sc1
    s_add_u32 s60, s60, 1024
    buffer_load_dwordx4 v[188:191], v4, s[4:7], s60 offen sc1
    s_add_u32 s60, s60, 1024
    buffer_load_dwordx4 v[192:195], v4, s[4:7], s60 offen sc1
    s_add_u32 s60, s60, 1024
    buffer_load_dwordx4 v[196:199], v4, s[4:7], s60 offen sc1
    s_add_u32 s60, s60, 1024
    buffer_load_dwordx4 v[200:203], v4, s[4:7], s60 offen sc1
    s_waitcnt vmcnt(0)
    v_add_f32 v168, v168, v172
    v_add_f32 v169, v169, v173
    v_add_f32 v170, v170, v174
    v_add_f32 v171, v171, v175
    v_add_f32 v168, v168, v176
    v_add_f32 v169, v169, v177
    v_add_f32 v170, v170, v178
    v_add_f32 v171, v171, v179
    v_add_f32 v168, v168, v180
    v_add_f32 v169, v169, v181
    v_add_f32 v170, v170, v182
    v_add_f32 v171, v171, v183
    v_add_f32 v168, v168, v184
    v_add_f32 v169, v169, v185
    v_add_f32 v170, v170, v186
    v_add_f32 v171, v171, v187
    v_add_f32 v168, v168, v188
    v_add_f32 v169, v169, v189
    v_add_f32 v170, v170, v190
    v_add_f32 v171, v171, v191
    v_add_f32 v168, v168, v192
    v_add_f32 v169, v169, v193
    v_add_f32 v170, v170, v194
    v_add_f32 v171, v171, v195
    v_add_f32 v168, v168, v196
    v_add_f32 v169, v169, v197
    v_add_f32 v170, v170, v198
    v_add_f32 v171, v171, v199
    v_add_f32 v168, v168, v200
    v_add_f32 v169, v169, v201
    v_add_f32 v170, v170, v202
    v_add_f32 v171, v171, v203
    v_mov_b32 v172, v168
    v_mov_b32 v173, v169
    v_mov_b32 v174, v170
    v_mov_b32 v175, v171
    v_permlane16_swap_b32 v168, v172
    v_permlane16_swap_b32 v169, v173
    v_permlane16_swap_b32 v170, v174
    v_permlane16_swap_b32 v171, v175
    v_add_f32 v168, v168, v172
    v_add_f32 v169, v169, v173
    v_add_f32 v170, v170, v174
    v_add_f32 v171, v171, v175
    v_mov_b32 v172, v168
    v_mov_b32 v173, v169
    v_mov_b32 v174, v170
    v_mov_b32 v175, v171
    v_permlane32_swap_b32 v168, v172
    v_permlane32_swap_b32 v169, v173
    v_permlane32_swap_b32 v170, v174
    v_permlane32_swap_b32 v171, v175
    v_add_f32 v168, v168, v172
    v_add_f32 v169, v169, v173
    v_add_f32 v170, v170, v174
    v_add_f32 v171, v171, v175
    v_and_b32 v4, 15, v2
    v_lshlrev_b32 v4, 4, v4
    v_add_u32 v4, 96000, v4
    ds_write_b128 v4, v[168:171]
    s_waitcnt lgkmcnt(0)
    s_branch L_qkv_pre
L_relayout:
L_rel_nx:
    s_mul_i32 s70, s24, 14
    s_add_u32 s70, s70, s25
    s_sub_u32 s70, s70, 18
    s_cmp_lt_u32 s26, 6
    s_cbranch_scc1 L_rel_nx1
    s_cmp_lt_u32 s70, 72
    s_cbranch_scc1 L_rel_nq
    s_cmp_ge_u32 s70, 90
    s_cbranch_scc1 L_rel_nx1
    s_mul_i32 s70, s24, 14
    s_add_u32 s70, s70, s25
    s_sub_u32 s70, s70, 18
    s_sub_u32 s62, s26, 6
    s_sub_u32 s71, s70, 72
    s_mul_i32 s60, s71, 41472
    s_sub_u32 s61, s71, 16
    s_mul_i32 s61, s61, 331776
    s_add_u32 s61, s61, 18432
    s_cmp_lt_u32 s71, 16
    s_cselect_b32 s60, s60, s61
    s_cselect_b64 s[74:75], -1, 0
    s_mov_b32 s12, s48
    s_mov_b32 s13, s49
    s_mov_b32 s14, 663552
    s_mov_b32 s15, 0x20000
L_14:
    v_lshl_add_u32 v4, s62, 6, v2
    v_lshrrev_b32 v9, 3, v4
    v_mul_hi_u32 v5, v9, s64
    v_mul_u32_u24 v6, 9, v5
    v_sub_u32 v6, v9, v6
    v_mul_u32_u24 v6, 72, v5
    v_sub_u32 v6, v4, v6
    v_lshrrev_b32 v7, 4, v5
    v_mul_u32_u24 v7, 18, v7
    v_bfe_u32 v8, v5, 3, 1
    v_lshl_add_u32 v7, v8, 2, v7
    v_bfe_u32 v8, v5, 2, 1
    v_lshl_add_u32 v7, v8, 3, v7
    v_and_b32 v8, 3, v5
    v_add_u32 v7, v7, v8
    v_lshrrev_b32 v8, 1, v5
    v_mul_u32_u24 v8, 18, v8
    v_and_b32 v9, 1, v5
    v_add_u32 v8, v8, v9
    v_cndmask_b32 v7, v8, v7, s[74:75]
    v_mul_u32_u24 v7, 1152, v7
    v_lshl_add_u32 v8, v6, 4, v7
    s_lshl_b32 m0, s62, 10
    s_add_u32 s62, s62, 2
    buffer_load_dwordx4 v8, s[12:15], s60 offen lds
    s_cmp_lt_u32 s62, 36
    s_cbranch_scc1 L_14
    s_branch L_rel_nx1
L_rel_nq:
    s_mul_i32 s70, s24, 14
    s_add_u32 s70, s70, s25
    s_sub_u32 s70, s70, 18
    s_sub_u32 s62, s26, 6
    s_lshr_b32 s71, s70, 1
    s_and_b32 s72, s70, 1
    s_mul_i32 s60, s71, 55296
    s_mul_i32 s61, s72, 576
    s_add_u32 s60, s60, s61
    s_add_u32 s60, s60, 4
    s_mov_b32 s12, s46
    s_mov_b32 s13, s47
    s_mov_b32 s14, 1990656
    s_mov_b32 s15, 0x20000
L_15:
    v_lshl_add_u32 v4, s62, 6, v2
    v_lshrrev_b32 v7, 2, v4
    v_mul_hi_u32 v5, v7, s64
    v_mul_u32_u24 v6, 9, v5
    v_sub_u32 v6, v7, v6
    v_mul_u32_u24 v5, 576, v5
    v_lshl_add_u32 v8, v4, 4, v5
    s_lshl_b32 s63, s62, 10
    s_add_u32 m0, s63, 27648
    s_add_u32 s62, s62, 2
    buffer_load_dwordx4 v8, s[12:15], s60 offen lds
    s_cmp_lt_u32 s62, 27
    s_cbranch_scc1 L_15
L_rel_nx1:
    s_waitcnt vmcnt(0)
    s_barrier
    v_lshrrev_b32 v3, 4, v2
    v_bfe_u32 v4, v2, 2, 2
    v_and_b32 v5, 3, v2
    v_lshrrev_b32 v6, 5, v2
    v_and_b32 v7, 31, v2
    s_cmp_ge_u32 s70, 90
    s_cbranch_scc1 L_rel_nf
    s_cmp_ge_u32 s70, 72
    s_cbranch_scc1 L_rel_o
    s_lshr_b32 s71, s70, 1
    s_and_b32 s72, s70, 1
    s_mul_i32 s73, s71, 1792
    s_mul_i32 s74, s72, 1032192
    s_add_u32 s73, s73, s74
    s_add_u32 s73, s73, 5242880
    v_lshl_add_u32 v8, v6, 3, v4
    v_mul_u32_u24 v8, 1728, v8
    v_and_b32 v9, 1, v3
    s_lshr_b32 s75, s26, 1
    s_and_b32 s76, s26, 1
    s_mul_i32 s77, s75, 36
    s_and_b32 s79, s75, 1
    s_mul_i32 s79, s79, 27644
    s_add_u32 s77, s77, s79
    s_mul_i32 s78, s75, 64512
    s_add_u32 s73, s73, s78
    s_cmp_lg_u32 s76, 0
    s_cbranch_scc1 L_rel_t1
    v_mul_u32_u24 v10, 576, v9
    v_lshl_add_u32 v10, v5, 3, v10
    v_add3_u32 v8, v8, v10, s77
    v_lshlrev_b32 v11, 4, v2
    v_lshlrev_b32 v14, 2, v7
    s_branch L_rel_go
L_rel_t1:
    v_lshlrev_b32 v10, 3, v5
    v_add_u32 v10, 1152, v10
    v_mov_b32 v12, 1184
    v_cmp_eq_u32 vcc, 1, v5
    s_nop 1
    v_cndmask_b32 v12, v12, 32, vcc
    v_mov_b32 v13, 608
    v_cmp_eq_u32 vcc, 2, v5
    s_nop 1
    v_cndmask_b32 v12, v12, v13, vcc
    v_cmp_eq_u32 vcc, 1, v9
    s_nop 1
    v_cndmask_b32 v10, v10, v12, vcc
    v_add3_u32 v8, v8, v10, s77
    v_subrev_u32 v12, 2, v7
    v_cmp_gt_u32 vcc, 22, v7
    s_nop 1
    v_cndmask_b32 v12, v12, v7, vcc
    v_lshlrev_b32 v14, 2, v12
    v_lshlrev_b32 v12, 4, v12
    v_mul_u32_u24 v13, 384, v6
    v_add_u32 v11, v12, v13
    v_add_u32 v11, 1024, v11
    v_and_b32 v13, 30, v7
    v_cmp_eq_u32 s[62:63], 24, v13
    s_nop 1
    s_or_b64 vcc, vcc, s[62:63]
    v_mov_b32 v13, 0x7fffffff
    s_nop 0
    v_cndmask_b32 v11, v13, v11, vcc
    v_cndmask_b32 v14, v13, v14, vcc
L_rel_go:
    ds_read_b64_tr_b16 v[68:69], v8 offset:0
    ds_read_b64_tr_b16 v[70:71], v8 offset:6912
    ds_read_b64_tr_b16 v[72:73], v8 offset:144
    ds_read_b64_tr_b16 v[74:75], v8 offset:7056
    ds_read_b64_tr_b16 v[76:77], v8 offset:288
    ds_read_b64_tr_b16 v[78:79], v8 offset:7200
    ds_read_b64_tr_b16 v[80:81], v8 offset:432
    ds_read_b64_tr_b16 v[82:83], v8 offset:7344
    s_lshl_b32 s74, s72, 4
    s_add_u32 s74, s74, s75
    s_mul_i32 s74, s74, 36
    s_add_u32 s74, s74, s71
    s_lshl_b32 s74, s74, 8
    s_lshl_b32 s77, s76, 7
    s_add_u32 s74, s74, s77
    s_add_u32 s74, s74, 1835008
    v_mov_b32 v15, 0x3f803f80
    v_mov_b32 v84, 0
    v_mov_b32 v85, 0
    v_mov_b32 v86, 0
    v_mov_b32 v87, 0
    s_waitcnt lgkmcnt(6)
    buffer_store_dwordx4 v[68:71], v11, s[4:7], s73 offen sc1
    s_add_u32 s73, s73, 258048
    v_dot2c_f32_bf16 v84, v68, v15
    v_dot2c_f32_bf16 v84, v69, v15
    v_dot2c_f32_bf16 v84, v70, v15
    v_dot2c_f32_bf16 v84, v71, v15
    s_waitcnt lgkmcnt(4)
    buffer_store_dwordx4 v[72:75], v11, s[4:7], s73 offen sc1
    s_add_u32 s73, s73, 258048
    v_dot2c_f32_bf16 v85, v72, v15
    v_dot2c_f32_bf16 v85, v73, v15
    v_dot2c_f32_bf16 v85, v74, v15
    v_dot2c_f32_bf16 v85, v75, v15
    s_waitcnt lgkmcnt(2)
    buffer_store_dwordx4 v[76:79], v11, s[4:7], s73 offen sc1
    s_add_u32 s73, s73, 258048
    v_dot2c_f32_bf16 v86, v76, v15
    v_dot2c_f32_bf16 v86, v77, v15
    v_dot2c_f32_bf16 v86, v78, v15
    v_dot2c_f32_bf16 v86, v79, v15
    s_waitcnt lgkmcnt(0)
    buffer_store_dwordx4 v[80:83], v11, s[4:7], s73 offen sc1
    s_add_u32 s73, s73, 258048
    v_dot2c_f32_bf16 v87, v80, v15
    v_dot2c_f32_bf16 v87, v81, v15
    v_dot2c_f32_bf16 v87, v82, v15
    v_dot2c_f32_bf16 v87, v83, v15
    v_mov_b32 v88, v84
    v_mov_b32 v89, v85
    v_mov_b32 v90, v86
    v_mov_b32 v91, v87
    v_permlane32_swap_b32 v84, v88
    v_permlane32_swap_b32 v85, v89
    v_permlane32_swap_b32 v86, v90
    v_permlane32_swap_b32 v87, v91
    v_add_f32 v84, v84, v88
    v_add_f32 v85, v85, v89
    v_add_f32 v86, v86, v90
    v_add_f32 v87, v87, v91
    s_mov_b32 s62, 0
    s_mov_b32 s63, -1
    v_mul_u32_u24 v13, 36864, v6
    v_add_u32 v14, v14, v13
    v_cndmask_b32 v84, v84, v85, s[62:63]
    v_cndmask_b32 v86, v86, v87, s[62:63]
    buffer_store_dword v84, v14, s[4:7], s74 offen sc1
    s_add_u32 s74, s74, 73728
    buffer_store_dword v86, v14, s[4:7], s74 offen sc1
    s_branch L_rel_fin
L_rel_o:
    s_sub_u32 s71, s70, 72
    s_mul_i32 s73, s26, 82944
    s_mul_i32 s74, s71, 4608
    s_add_u32 s73, s73, s74
    s_add_u32 s73, s73, 7340032
    v_lshl_add_u32 v10, v3, 3, v4
    v_mul_u32_u24 v10, 1152, v10
    s_mul_i32 s74, s26, 144
    v_add_u32 v10, s74, v10
    v_lshl_add_u32 v11, v5, 3, v10
    v_lshl_add_u32 v10, v5, 4, v10
    v_lshlrev_b32 v12, 4, v2
    v_and_b32 v13, 15, v2
    v_lshlrev_b32 v14, 4, v13
    v_lshl_add_u32 v14, v3, 7, v14
    v_mov_b32 v15, 0x7fffffff
    v_cmp_gt_u32 vcc, 8, v13
    s_add_u32 s74, s73, 4096
    s_nop 0
    v_cndmask_b32 v14, v15, v14, vcc
    ds_read_b64_tr_b16 v[68:69], v10 offset:0
    ds_read_b64_tr_b16 v[70:71], v10 offset:4608
    ds_read_b64_tr_b16 v[72:73], v10 offset:8
    ds_read_b64_tr_b16 v[74:75], v10 offset:4616
    ds_read_b64_tr_b16 v[76:77], v10 offset:64
    ds_read_b64_tr_b16 v[78:79], v10 offset:4672
    ds_read_b64_tr_b16 v[80:81], v10 offset:72
    ds_read_b64_tr_b16 v[82:83], v10 offset:4680
    ds_read_b64_tr_b16 v[84:85], v11 offset:128
    ds_read_b64_tr_b16 v[86:87], v11 offset:4736
    s_waitcnt lgkmcnt(8)
    buffer_store_dwordx4 v[68:71], v12, s[4:7], s73 offen offset:0 sc1
    s_waitcnt lgkmcnt(6)
    buffer_store_dwordx4 v[72:75], v12, s[4:7], s73 offen offset:1024 sc1
    s_waitcnt lgkmcnt(4)
    buffer_store_dwordx4 v[76:79], v12, s[4:7], s73 offen offset:2048 sc1
    s_waitcnt lgkmcnt(2)
    buffer_store_dwordx4 v[80:83], v12, s[4:7], s73 offen offset:3072 sc1
    s_waitcnt lgkmcnt(0)
    buffer_store_dwordx4 v[84:87], v14, s[4:7], s74 offen sc1
L_rel_fin:
    s_waitcnt vmcnt(0)
    s_barrier
    s_cmp_lg_u32 s26, 0
    s_cbranch_scc1 L_rel_nf
    s_lshl_b32 s60, s70, 6
    s_add_u32 s60, s60, 20480
    v_mov_b32 v10, s28
    v_mov_b32 v11, s29
    v_mov_b32 v12, 0
    s_mov_b64 exec, 1
    buffer_store_dwordx2 v[10:11], v12, s[4:7], s60 offen sc1
    s_mov_b64 exec, -1
L_rel_nf:
    s_cmp_lt_u32 s26, 4
    s_cbranch_scc1 L_rel_nw
    s_lshr_b32 s60, s25, 4
    v_min_u32 v5, 35, v2
    v_lshl_add_u32 v5, v5, 1, s60
    v_lshlrev_b32 v5, 6, v5
    s_mov_b32 s62, 20480
    s_mov_b32 s96, 400000
    s_mov_b64 exec, 1
Lp1_19:
    buffer_load_dwordx2 v[6:7], v5, s[4:7], s62 offen offset:0 sc1
    s_waitcnt vmcnt(0)
    v_cmp_eq_u64 vcc, s[28:29], v[6:7]
    s_nop 0
    s_cmp_lg_u64 vcc, 0
    s_cbranch_scc1 Lp1d_20
    s_sleep 4
    s_sub_u32 s96, s96, 1
    s_cmp_gt_u32 s96, 1
    s_cbranch_scc1 Lp1_19
Lp1d_20:
    s_mov_b64 exec, -1
Lpoll_17:
    buffer_load_dwordx2 v[6:7], v5, s[4:7], s62 offen offset:0 sc1
    s_waitcnt vmcnt(0)
    v_cmp_ne_u64 vcc, s[28:29], v[6:7]
    s_nop 0
    s_cmp_eq_u64 vcc, 0
    s_cbranch_scc1 Lpolld_18
    s_mov_b64 exec, vcc
    s_sleep 1
    s_sub_u32 s96, s96, 1
    s_cmp_lg_u32 s96, 0
    s_cbranch_scc1 Lpoll_17
    v_mov_b32 v6, 3
    v_mov_b32 v7, 0
    global_store_dword v7, v6, s[52:53]
    s_waitcnt vmcnt(0)
Lpolld_18:
    s_mov_b64 exec, -1
    s_mul_i32 s60, s25, 64512
    s_add_u32 s60, s60, 5242880
    s_sub_u32 s62, s26, 4
    s_add_u32 s62, s62, 0
    v_lshlrev_b32 v4, 4, v2
L_21:
    s_lshl_b32 s63, s62, 10
    s_add_u32 m0, s63, 99328
    s_add_u32 s63, s63, s60
    s_add_u32 s62, s62, 4
    buffer_load_dwordx4 v4, s[4:7], s63 offen sc1  lds
    s_cmp_lt_u32 s62, 63
    s_cbranch_scc1 L_21
    s_cmp_lg_u32 s26, 7
    s_cbranch_scc1 L_rel_nw
    s_mul_i32 s60, s25, 9216
    s_add_u32 s60, s60, 1835008
    v_lshlrev_b32 v4, 4, v2
    buffer_load_dwordx4 v[168:171], v4, s[4:7], s60 offen sc1
    s_add_u32 s60, s60, 1024
    buffer_load_dwordx4 v[172:175], v4, s[4:7], s60 offen sc1
    s_add_u32 s60, s60, 1024
    buffer_load_dwordx4 v[176:179], v4, s[4:7], s60 offen sc1
    s_add_u32 s60, s60, 1024
    buffer_load_dwordx4 v[180:183], v4, s[4:7], s60 offen sc1
    s_add_u32 s60, s60, 1024
    buffer_load_dwordx4 v[184:187], v4, s[4:7], s60 offen sc1
    s_add_u32 s60, s60, 1024
    buffer_load_dwordx4 v[188:191], v4, s[4:7], s60 offen sc1
    s_add_u32 s60, s60, 1024
    buffer_load_dwordx4 v[192:195], v4, s[4:7], s60 offen sc1
    s_add_u32 s60, s60, 1024
    buffer_load_dwordx4 v[196:199], v4, s[4:7], s60 offen sc1
    s_add_u32 s60, s60, 1024
    buffer_load_dwordx4 v[200:203], v4, s[4:7], s60 offen sc1
    s_waitcnt vmcnt(0)
    v_add_f32 v168, v168, v172
    v_add_f32 v169, v169, v173
    v_add_f32 v170, v170, v174
    v_add_f32 v171, v171, v175
    v_add_f32 v168, v168, v176
    v_add_f32 v169, v169, v177
    v_add_f32 v170, v170, v178
    v_add_f32 v171, v171, v179
    v_add_f32 v168, v168, v180
    v_add_f32 v169, v169, v181
    v_add_f32 v170, v170, v182
    v_add_f32 v171, v171, v183
    v_add_f32 v168, v168, v184
    v_add_f32 v169, v169, v185
    v_add_f32 v170, v170, v186
    v_add_f32 v171, v171, v187
    v_add_f32 v168, v168, v188
    v_add_f32 v169, v169, v189
    v_add_f32 v170, v170, v190
    v_add_f32 v171, v171, v191
    v_add_f32 v168, v168, v192
    v_add_f32 v169, v169, v193
    v_add_f32 v170, v170, v194
    v_add_f32 v171, v171, v195
    v_add_f32 v168, v168, v196
    v_add_f32 v169, v169, v197
    v_add_f32 v170, v170, v198
    v_add_f32 v171, v171, v199
    v_add_f32 v168, v168, v200
    v_add_f32 v169, v169, v201
    v_add_f32 v170, v170, v202
    v_add_f32 v171, v171, v203
    v_mov_b32 v172, v168
    v_mov_b32 v173, v169
    v_mov_b32 v174, v170
    v_mov_b32 v175, v171
    v_permlane16_swap_b32 v168, v172
    v_permlane16_swap_b32 v169, v173
    v_permlane16_swap_b32 v170, v174
    v_permlane16_swap_b32 v171, v175
    v_add_f32 v168, v168, v172
    v_add_f32 v169, v169, v173
    v_add_f32 v170, v170, v174
    v_add_f32 v171, v171, v175
    v_mov_b32 v172, v168
    v_mov_b32 v173, v169
    v_mov_b32 v174, v170
    v_mov_b32 v175, v171
    v_permlane32_swap_b32 v168, v172
    v_permlane32_swap_b32 v169, v173
    v_permlane32_swap_b32 v170, v174
    v_permlane32_swap_b32 v171, v175
    v_add_f32 v168, v168, v172
    v_add_f32 v169, v169, v173
    v_add_f32 v170, v170, v174
    v_add_f32 v171, v171, v175
    v_and_b32 v4, 15, v2
    v_lshlrev_b32 v4, 4, v4
    v_add_u32 v4, 96000, v4
    ds_write_b128 v4, v[168:171]
    s_waitcnt lgkmcnt(0)
L_rel_nw:
    s_waitcnt vmcnt(0)
    s_barrier
    s_branch L_qkv_pre
L_qkv_pre:
    v_lshlrev_b32 v4, 4, v2
    v_add_u32 v4, 99328, v4
    v_and_b32 v6, 31, v2
    v_cmp_gt_u32 vcc, 24, v6
    v_lshrrev_b32 v7, 5, v2
    s_nop 0
    v_cndmask_b32 v5, 23, v6, vcc
    v_lshlrev_b32 v5, 4, v5
    v_mul_u32_u24 v53, 384, v7
    v_add_u32 v5, v5, v53
    v_add_u32 v5, 100352, v5
    v_and_b32 v53, 15, v2
    v_lshlrev_b32 v53, 1, v53
    v_bfe_u32 v54, v2, 4, 1
    v_add_u32 v53, v53, v54
    v_lshlrev_b32 v53, 4, v53
    v_and_b32 v58, 19, v6
    v_bfe_u32 v54, v6, 2, 1
    v_lshl_add_u32 v58, v54, 3, v58
    v_bfe_u32 v54, v6, 3, 1
    v_lshl_add_u32 v58, v54, 2, v58
    v_lshlrev_b32 v54, 4, v58
    v_lshl_add_u32 v54, v7, 9, v54
    s_lshl_b32 s61, s30, 10
    v_add_u32 v54, s61, v54
    v_min_u32 v56, 19, v6
    v_cmp_eq_u32 vcc, 4, v56
    v_cmp_eq_u32 s[62:63], 19, v56
    s_mul_i32 s61, s30, 1280
    s_add_u32 s61, s61, 8192
    v_cndmask_b32 v56, v56, 19, vcc
    v_cndmask_b32 v56, v56, 4, s[62:63]
    v_lshlrev_b32 v56, 4, v56
    v_mul_u32_u24 v55, 320, v7
    v_add_u32 v56, v56, v55
    v_add_u32 v55, s61, v56
    s_lshl_b32 s62, s30, 7
    s_add_u32 s63, s62, 98304
    s_add_u32 s62, s62, 18432
    v_mov_b32 v59, s62
    v_mov_b32 v60, s63
    v_cmp_gt_u32 vcc, 22, v6
    v_and_b32 v57, 1, v6
    v_lshlrev_b32 v57, 1, v57
    v_lshl_add_u32 v57, v7, 5, v57
    v_cndmask_b32 v61, v59, v60, vcc
    v_add_u32 v57, v57, v61
    v_lshl_add_u32 v58, v58, 2, v60
    v_lshl_add_u32 v59, v6, 2, v59
    s_lshl_b32 s60, s26, 8
    s_add_u32 s60, s60, 96256
    v_lshl_add_u32 v60, v6, 2, s60
    v_mov_b32 v61, s60
    v_and_b32 v62, 30, v6
    v_cmp_eq_u32 vcc, 20, v62
    v_add_u32 v62, 128, v61
    s_nop 0
    v_cndmask_b32 v61, v61, v62, vcc
    v_cmp_eq_u32 vcc, 18, v6
    v_lshl_add_u32 v61, v7, 4, v61
    v_mov_b32 v62, 0x3f803f80
    v_cndmask_b32 v62, 0, v62, vcc
    s_lshl_b32 s69, s27, 5
    s_add_u32 s69, s69, s25
    s_lshl_b32 s69, s69, 3
    s_add_u32 s89, s69, s24
    s_mul_i32 s89, s89, 19456
    s_add_u32 s89, s89, 17825792
    s_mov_b32 s73, 0x7b800000
    s_mov_b32 s74, 0x7b800000
    s_cmp_lg_u32 s26, 0
    s_cbranch_scc1 L_22
    v_lshlrev_b32 v8, 8, v2
    v_add_u32 v9, 16384, v8
    v_add_u32 v10, 32768, v8
    v_min_u32 v10, 36608, v10
    s_lshr_b32 s60, s24, 1
    s_lshl_b32 s60, s60, 6
    s_add_u32 s60, s60, 32768
    s_mov_b32 s96, 400000
    s_mov_b64 exec, 1
Lp1_25:
    buffer_load_dwordx2 v[220:221], v8, s[4:7], s60 offen offset:0 sc1
    s_waitcnt vmcnt(0)
    v_cmp_eq_u64 vcc, s[28:29], v[220:221]
    s_nop 0
    s_cmp_lg_u64 vcc, 0
    s_cbranch_scc1 Lp1d_26
    s_sleep 2
    s_sub_u32 s96, s96, 1
    s_cmp_gt_u32 s96, 1
    s_cbranch_scc1 Lp1_25
Lp1d_26:
    s_mov_b64 exec, -1
Lpoll_23:
    buffer_load_dwordx2 v[220:221], v8, s[4:7], s60 offen offset:0 sc1
    buffer_load_dwordx2 v[222:223], v9, s[4:7], s60 offen offset:0 sc1
    buffer_load_dwordx2 v[224:225], v10, s[4:7], s60 offen offset:0 sc1
    s_waitcnt vmcnt(0)
    v_cmp_ne_u64 vcc, s[28:29], v[220:221]
    v_cmp_ne_u64 s[94:95], s[28:29], v[222:223]
    s_nop 0
    s_or_b64 vcc, vcc, s[94:95]
    v_cmp_ne_u64 s[94:95], s[28:29], v[224:225]
    s_nop 0
    s_or_b64 vcc, vcc, s[94:95]
    s_cmp_eq_u64 vcc, 0
    s_cbranch_scc1 Lpolld_24
    s_mov_b64 exec, vcc
    s_sub_u32 s96, s96, 1
    s_cmp_lg_u32 s96, 0
    s_cbranch_scc1 Lpoll_23
    v_mov_b32 v220, 4
    v_mov_b32 v221, 0
    global_store_dword v221, v220, s[52:53]
    s_waitcnt vmcnt(0)
Lpolld_24:
    s_mov_b64 exec, -1
L_22:
    s_mov_b32 s68, 8388608
    s_cmp_eq_u32 s26, 0
    s_cselect_b32 s3, 3, 0
    s_add_u32 s88, s26, 59
    s_lshl_b32 s88, s88, 10
    s_mul_i32 s87, s25, 64512
    s_add_u32 s87, s87, s88
    s_add_u32 s87, s87, 5242880
    s_cmp_lt_u32 s25, 18
    s_cselect_b32 s87, s87, 0
    s_cmp_ge_u32 s26, 4
    s_cselect_b32 s87, s87, 0
L_qkv:
    s_lshl_b32 s75, s27, 15
    s_lshl_b32 s61, s24, 12
    s_add_u32 s75, s75, s61
    s_add_u32 s75, s75, 1048576
    s_mul_i32 s60, s24, 294912
    s_add_u32 s60, s60, s68
    s_cmp_lg_u32 s3, 3
    s_cbranch_scc1 L_qkv_ns
    v_lshrrev_b32 v10, 2, v2
    v_and_b32 v11, 3, v2
    v_lshlrev_b32 v10, 8, v10
    v_lshl_add_u32 v10, v11, 4, v10
    s_lshr_b32 s61, s25, 2
    s_mul_i32 s61, s61, 36864
    s_and_b32 s62, s25, 3
    s_lshl_b32 s62, s62, 6
    s_add_u32 s61, s61, s62
    s_add_u32 s61, s61, s60
    buffer_load_dwordx4 v[16:19], v10, s[4:7], s61 offen sc1
    s_add_u32 s61, s61, 4096
    buffer_load_dwordx4 v[20:23], v10, s[4:7], s61 offen sc1
    s_add_u32 s61, s61, 4096
    buffer_load_dwordx4 v[24:27], v10, s[4:7], s61 offen sc1
    s_add_u32 s61, s61, 4096
    buffer_load_dwordx4 v[28:31], v10, s[4:7], s61 offen sc1
    s_add_u32 s61, s61, 4096
    buffer_load_dwordx4 v[32:35], v10, s[4:7], s61 offen sc1
    s_add_u32 s61, s61, 4096
    buffer_load_dwordx4 v[36:39], v10, s[4:7], s61 offen sc1
    s_add_u32 s61, s61, 4096
    buffer_load_dwordx4 v[40:43], v10, s[4:7], s61 offen sc1
    s_add_u32 s61, s61, 4096
    buffer_load_dwordx4 v[44:47], v10, s[4:7], s61 offen sc1
    s_add_u32 s61, s61, 4096
    buffer_load_dwordx4 v[48:51], v10, s[4:7], s61 offen sc1
L_qkv_ns:
    v_lshlrev_b32 v8, 4, v2
    s_mul_i32 s61, s30, 36864
    s_add_u32 s60, s60, s61
    s_barrier
    buffer_load_dwordx4 v[64:67], v8, s[4:7], s60 offen offset:0 sc1
    buffer_load_dwordx4 v[68:71], v8, s[4:7], s60 offen offset:1024 sc1
    buffer_load_dwordx4 v[72:75], v8, s[4:7], s60 offen offset:2048 sc1
    buffer_load_dwordx4 v[76:79], v8, s[4:7], s60 offen offset:3072 sc1
    s_add_u32 s60, s60, 4096
    buffer_load_dwordx4 v[80:83], v8, s[4:7], s60 offen offset:0 sc1
    buffer_load_dwordx4 v[84:87], v8, s[4:7], s60 offen offset:1024 sc1
    buffer_load_dwordx4 v[88:91], v8, s[4:7], s60 offen offset:2048 sc1
    buffer_load_dwordx4 v[92:95], v8, s[4:7], s60 offen offset:3072 sc1
    s_add_u32 s60, s60, 4096
    s_cmp_lg_u32 s3, 3
    s_cbranch_scc1 L_qkv_ns2
    v_mov_b32 v12, 0
    v_mov_b32 v13, 0
    v_mov_b32 v14, 0
    v_mov_b32 v15, 0
    v_mov_b32 v52, 0x3f803f80
    s_waitcnt vmcnt(16)
    v_dot2c_f32_bf16 v12, v16, v52
    v_dot2c_f32_bf16 v13, v16, v16
    v_dot2c_f32_bf16 v12, v17, v52
    v_dot2c_f32_bf16 v13, v17, v17
    v_dot2c_f32_bf16 v14, v18, v52
    v_dot2c_f32_bf16 v15, v18, v18
    v_dot2c_f32_bf16 v14, v19, v52
    v_dot2c_f32_bf16 v15, v19, v19
    s_waitcnt vmcnt(15)
    v_dot2c_f32_bf16 v12, v20, v52
    v_dot2c_f32_bf16 v13, v20, v20
    v_dot2c_f32_bf16 v12, v21, v52
    v_dot2c_f32_bf16 v13, v21, v21
    v_dot2c_f32_bf16 v14, v22, v52
    v_dot2c_f32_bf16 v15, v22, v22
    v_dot2c_f32_bf16 v14, v23, v52
    v_dot2c_f32_bf16 v15, v23, v23
    s_waitcnt vmcnt(14)
    v_dot2c_f32_bf16 v12, v24, v52
    v_dot2c_f32_bf16 v13, v24, v24
    v_dot2c_f32_bf16 v12, v25, v52
    v_dot2c_f32_bf16 v13, v25, v25
    v_dot2c_f32_bf16 v14, v26, v52
    v_dot2c_f32_bf16 v15, v26, v26
    v_dot2c_f32_bf16 v14, v27, v52
    v_dot2c_f32_bf16 v15, v27, v27
    s_waitcnt vmcnt(13)
    v_dot2c_f32_bf16 v12, v28, v52
    v_dot2c_f32_bf16 v13, v28, v28
    v_dot2c_f32_bf16 v12, v29, v52
    v_dot2c_f32_bf16 v13, v29, v29
    v_dot2c_f32_bf16 v14, v30, v52
    v_dot2c_f32_bf16 v15, v30, v30
    v_dot2c_f32_bf16 v14, v31, v52
    v_dot2c_f32_bf16 v15, v31, v31
    s_waitcnt vmcnt(12)
    v_dot2c_f32_bf16 v12, v32, v52
    v_dot2c_f32_bf16 v13, v32, v32
    v_dot2c_f32_bf16 v12, v33, v52
    v_dot2c_f32_bf16 v13, v33, v33
    v_dot2c_f32_bf16 v14, v34, v52
    v_dot2c_f32_bf16 v15, v34, v34
    v_dot2c_f32_bf16 v14, v35, v52
    v_dot2c_f32_bf16 v15, v35, v35
    s_waitcnt vmcnt(11)
    v_dot2c_f32_bf16 v12, v36, v52
    v_dot2c_f32_bf16 v13, v36, v36
    v_dot2c_f32_bf16 v12, v37, v52
    v_dot2c_f32_bf16 v13, v37, v37
    v_dot2c_f32_bf16 v14, v38, v52
    v_dot2c_f32_bf16 v15, v38, v38
    v_dot2c_f32_bf16 v14, v39, v52
    v_dot2c_f32_bf16 v15, v39, v39
    s_waitcnt vmcnt(10)
    v_dot2c_f32_bf16 v12, v40, v52
    v_dot2c_f32_bf16 v13, v40, v40
    v_dot2c_f32_bf16 v12, v41, v52
    v_dot2c_f32_bf16 v13, v41, v41
    v_dot2c_f32_bf16 v14, v42, v52
    v_dot2c_f32_bf16 v15, v42, v42
    v_dot2c_f32_bf16 v14, v43, v52
    v_dot2c_f32_bf16 v15, v43, v43
    s_waitcnt vmcnt(9)
    v_dot2c_f32_bf16 v12, v44, v52
    v_dot2c_f32_bf16 v13, v44, v44
    v_dot2c_f32_bf16 v12, v45, v52
    v_dot2c_f32_bf16 v13, v45, v45
    v_dot2c_f32_bf16 v14, v46, v52
    v_dot2c_f32_bf16 v15, v46, v46
    v_dot2c_f32_bf16 v14, v47, v52
    v_dot2c_f32_bf16 v15, v47, v47
    s_waitcnt vmcnt(8)
    v_dot2c_f32_bf16 v12, v48, v52
    v_dot2c_f32_bf16 v13, v48, v48
    v_dot2c_f32_bf16 v12, v49, v52
    v_dot2c_f32_bf16 v13, v49, v49
    v_dot2c_f32_bf16 v14, v50, v52
    v_dot2c_f32_bf16 v15, v50, v50
    v_dot2c_f32_bf16 v14, v51, v52
    v_dot2c_f32_bf16 v15, v51, v51
    v_add_f32_dpp v12, v12, v12 row_ror:4 row_mask:0xf bank_mask:0xf bound_ctrl:0
    v_add_f32_dpp v13, v13, v13 row_ror:4 row_mask:0xf bank_mask:0xf bound_ctrl:0
    v_add_f32_dpp v14, v14, v14 row_ror:4 row_mask:0xf bank_mask:0xf bound_ctrl:0
    v_add_f32_dpp v15, v15, v15 row_ror:4 row_mask:0xf bank_mask:0xf bound_ctrl:0
    v_add_f32_dpp v12, v12, v12 row_ror:8 row_mask:0xf bank_mask:0xf bound_ctrl:0
    v_add_f32_dpp v13, v13, v13 row_ror:8 row_mask:0xf bank_mask:0xf bound_ctrl:0
    v_add_f32_dpp v14, v14, v14 row_ror:8 row_mask:0xf bank_mask:0xf bound_ctrl:0
    v_add_f32_dpp v15, v15, v15 row_ror:8 row_mask:0xf bank_mask:0xf bound_ctrl:0
    v_mov_b32 v16, v12
    v_mov_b32 v17, v13
    v_mov_b32 v18, v14
    v_mov_b32 v19, v15
    v_permlane16_swap_b32 v12, v16
    v_permlane16_swap_b32 v13, v17
    v_permlane16_swap_b32 v14, v18
    v_permlane16_swap_b32 v15, v19
    v_add_f32 v12, v12, v16
    v_add_f32 v13, v13, v17
    v_add_f32 v14, v14, v18
    v_add_f32 v15, v15, v19
    v_mov_b32 v16, v12
    v_mov_b32 v17, v13
    v_mov_b32 v18, v14
    v_mov_b32 v19, v15
    v_permlane32_swap_b32 v12, v16
    v_permlane32_swap_b32 v13, v17
    v_permlane32_swap_b32 v14, v18
    v_permlane32_swap_b32 v15, v19
    v_add_f32 v12, v12, v16
    v_add_f32 v13, v13, v17
    v_add_f32 v14, v14, v18
    v_add_f32 v15, v15, v19
    v_mul_f32 v12, 0x3ae38e39, v12
    v_mul_f32 v13, 0x3ae38e39, v13
    v_fma_f32 v23, -v12, v12, v13
    v_max_f32 v23, 0, v23
    v_add_f32 v23, 0x3727c5ac, v23
    v_rsq_f32 v17, v23
    s_nop 0
    v_mul_f32 v22, v12, v17
    v_sub_f32 v22, 0, v22
    v_mul_f32 v14, 0x3ae38e39, v14
    v_mul_f32 v15, 0x3ae38e39, v15
    v_fma_f32 v23, -v14, v14, v15
    v_max_f32 v23, 0, v23
    v_add_f32 v23, 0x3727c5ac, v23
    v_rsq_f32 v21, v23
    s_nop 0
    v_mul_f32 v22, v14, v21
    v_sub_f32 v22, 0, v22
    v_sub_f32 v16, 0, v12
    v_sub_f32 v20, 0, v14
    v_mov_b32 v18, s28
    v_mov_b32 v19, s29
    v_mov_b32 v22, s28
    v_mov_b32 v23, s29
    v_lshlrev_b32 v11, 5, v11
    s_lshl_b32 s61, s25, 7
    s_add_u32 s61, s61, s75
    s_mov_b64 exec, 15
    buffer_store_dwordx4 v[16:19], v11, s[4:7], s61 offen sc1
    buffer_store_dwordx4 v[20:23], v11, s[4:7], s61 offen offset:16 sc1
    s_mov_b64 exec, -1
L_qkv_ns2:
    v_lshlrev_b32 v9, 2, v6
    v_add_u32 v10, 96000, v9
    ds_read_b32 v250, v10
    ds_read_b32 v252, v10 offset:128
    s_lshl_b32 s61, s30, 9
    s_add_u32 s75, s75, s61
    s_mov_b32 s64, 0xffff0000
    s_waitcnt lgkmcnt(0)
    v_and_b32 v9, s64, v250
    v_sub_f32 v10, v250, v9
    v_cvt_pk_bf16_f32 v250, v9, v9
    v_cvt_pk_bf16_f32 v251, v10, 0
    v_and_b32 v9, s64, v252
    v_sub_f32 v10, v252, v9
    v_cvt_pk_bf16_f32 v252, v9, v9
    v_cvt_pk_bf16_f32 v253, v10, 0
    ds_read_b128 v[208:211], v4 offset:0
    ds_read_b128 v[212:215], v5 offset:0
    ds_read_b128 v[216:219], v4 offset:1792
    ds_read_b128 v[220:223], v5 offset:1792
    s_waitcnt vmcnt(7)
    v_permlane16_swap_b32 v64, v66
    v_permlane16_swap_b32 v65, v67
    s_setprio 3
    buffer_load_dwordx4 v[96:99], v8, s[4:7], s60 offen offset:0 sc1
    s_waitcnt vmcnt(7)
    v_permlane16_swap_b32 v68, v70
    v_permlane16_swap_b32 v69, v71
    s_waitcnt lgkmcnt(2)
    v_mfma_f32_32x32x16_bf16 v[16:31], v[208:211], v[64:67], 0
    v_mfma_f32_32x32x16_bf16 v[32:47], v[64:67], v[212:215], 0
    ds_read_b128 v[224:227], v4 offset:3584
    ds_read_b128 v[228:231], v5 offset:3584
    buffer_load_dwordx4 v[100:103], v8, s[4:7], s60 offen offset:1024 sc1
    s_waitcnt vmcnt(7)
    v_permlane16_swap_b32 v72, v74
    v_permlane16_swap_b32 v73, v75
    s_waitcnt lgkmcnt(2)
    v_mfma_f32_32x32x16_bf16 v[16:31], v[216:219], v[68:71], v[16:31]
    v_mfma_f32_32x32x16_bf16 v[32:47], v[68:71], v[220:223], v[32:47]
    ds_read_b128 v[208:211], v4 offset:5376
    ds_read_b128 v[212:215], v5 offset:5376
    buffer_load_dwordx4 v[104:107], v8, s[4:7], s60 offen offset:2048 sc1
    s_waitcnt vmcnt(7)
    v_permlane16_swap_b32 v76, v78
    v_permlane16_swap_b32 v77, v79
    s_waitcnt lgkmcnt(2)
    v_mfma_f32_32x32x16_bf16 v[16:31], v[224:227], v[72:75], v[16:31]
    v_mfma_f32_32x32x16_bf16 v[32:47], v[72:75], v[228:231], v[32:47]
    ds_read_b128 v[216:219], v4 offset:7168
    ds_read_b128 v[220:223], v5 offset:7168
    buffer_load_dwordx4 v[108:111], v8, s[4:7], s60 offen offset:3072 sc1
    s_add_u32 s60, s60, 4096
    s_waitcnt vmcnt(7)
    v_permlane16_swap_b32 v80, v82
    v_permlane16_swap_b32 v81, v83
    s_waitcnt lgkmcnt(2)
    v_mfma_f32_32x32x16_bf16 v[16:31], v[208:211], v[76:79], v[16:31]
    v_mfma_f32_32x32x16_bf16 v[32:47], v[76:79], v[212:215], v[32:47]
    ds_read_b128 v[224:227], v4 offset:8960
    ds_read_b128 v[228:231], v5 offset:8960
    buffer_load_dwordx4 v[112:115], v8, s[4:7], s60 offen offset:0 sc1
    s_waitcnt vmcnt(7)
    v_permlane16_swap_b32 v84, v86
    v_permlane16_swap_b32 v85, v87
    s_waitcnt lgkmcnt(2)
    v_mfma_f32_32x32x16_bf16 v[16:31], v[216:219], v[80:83], v[16:31]
    v_mfma_f32_32x32x16_bf16 v[32:47], v[80:83], v[220:223], v[32:47]
    ds_read_b128 v[208:211], v4 offset:10752
    ds_read_b128 v[212:215], v5 offset:10752
    buffer_load_dwordx4 v[116:119], v8, s[4:7], s60 offen offset:1024 sc1
    s_waitcnt vmcnt(7)
    v_permlane16_swap_b32 v88, v90
    v_permlane16_swap_b32 v89, v91
    s_waitcnt lgkmcnt(2)
    v_mfma_f32_32x32x16_bf16 v[16:31], v[224:227], v[84:87], v[16:31]
    v_mfma_f32_32x32x16_bf16 v[32:47], v[84:87], v[228:231], v[32:47]
    ds_read_b128 v[216:219], v4 offset:12544
    ds_read_b128 v[220:223], v5 offset:12544
    buffer_load_dwordx4 v[120:123], v8, s[4:7], s60 offen offset:2048 sc1
    s_waitcnt vmcnt(7)
    v_permlane16_swap_b32 v92, v94
    v_permlane16_swap_b32 v93, v95
    s_waitcnt lgkmcnt(2)
    v_mfma_f32_32x32x16_bf16 v[16:31], v[208:211], v[88:91], v[16:31]
    v_mfma_f32_32x32x16_bf16 v[32:47], v[88:91], v[212:215], v[32:47]
    ds_read_b128 v[224:227], v4 offset:14336
    ds_read_b128 v[228:231], v5 offset:14336
    buffer_load_dwordx4 v[124:127], v8, s[4:7], s60 offen offset:3072 sc1
    s_add_u32 s60, s60, 4096
    s_waitcnt vmcnt(7)
    v_permlane16_swap_b32 v96, v98
    v_permlane16_swap_b32 v97, v99
    s_waitcnt lgkmcnt(2)
    v_mfma_f32_32x32x16_bf16 v[16:31], v[216:219], v[92:95], v[16:31]
    v_mfma_f32_32x32x16_bf16 v[32:47], v[92:95], v[220:223], v[32:47]
    ds_read_b128 v[208:211], v4 offset:16128
    ds_read_b128 v[212:215], v5 offset:16128
    buffer_load_dwordx4 v[128:131], v8, s[4:7], s60 offen offset:0 sc1
    s_waitcnt vmcnt(7)
    v_permlane16_swap_b32 v100, v102
    v_permlane16_swap_b32 v101, v103
    s_waitcnt lgkmcnt(2)
    v_mfma_f32_32x32x16_bf16 v[16:31], v[224:227], v[96:99], v[16:31]
    v_mfma_f32_32x32x16_bf16 v[32:47], v[96:99], v[228:231], v[32:47]
    ds_read_b128 v[216:219], v4 offset:17920
    ds_read_b128 v[220:223], v5 offset:17920
    s_setprio 2
    buffer_load_dwordx4 v[132:135], v8, s[4:7], s60 offen offset:1024 sc1
    s_waitcnt vmcnt(7)
    v_permlane16_swap_b32 v104, v106
    v_permlane16_swap_b32 v105, v107
    s_waitcnt lgkmcnt(2)
    v_mfma_f32_32x32x16_bf16 v[16:31], v[208:211], v[100:103], v[16:31]
    v_mfma_f32_32x32x16_bf16 v[32:47], v[100:103], v[212:215], v[32:47]
    ds_read_b128 v[224:227], v4 offset:19712
    ds_read_b128 v[228:231], v5 offset:19712
    buffer_load_dwordx4 v[136:139], v8, s[4:7], s60 offen offset:2048 sc1
    s_waitcnt vmcnt(7)
    v_permlane16_swap_b32 v108, v110
    v_permlane16_swap_b32 v109, v111
    s_waitcnt lgkmcnt(2)
    v_mfma_f32_32x32x16_bf16 v[16:31], v[216:219], v[104:107], v[16:31]
    v_mfma_f32_32x32x16_bf16 v[32:47], v[104:107], v[220:223], v[32:47]
    ds_read_b128 v[208:211], v4 offset:21504
    ds_read_b128 v[212:215], v5 offset:21504
    buffer_load_dwordx4 v[140:143], v8, s[4:7], s60 offen offset:3072 sc1
    s_add_u32 s60, s60, 4096
    s_waitcnt vmcnt(7)
    v_permlane16_swap_b32 v112, v114
    v_permlane16_swap_b32 v113, v115
    s_waitcnt lgkmcnt(2)
    v_mfma_f32_32x32x16_bf16 v[16:31], v[224:227], v[108:111], v[16:31]
    v_mfma_f32_32x32x16_bf16 v[32:47], v[108:111], v[228:231], v[32:47]
    ds_read_b128 v[216:219], v4 offset:23296
    ds_read_b128 v[220:223], v5 offset:23296
    buffer_load_dwordx4 v[144:147], v8, s[4:7], s60 offen offset:0 sc1
    s_waitcnt vmcnt(7)
    v_permlane16_swap_b32 v116, v118
    v_permlane16_swap_b32 v117, v119
    s_waitcnt lgkmcnt(2)
    v_mfma_f32_32x32x16_bf16 v[16:31], v[208:211], v[112:115], v[16:31]
    v_mfma_f32_32x32x16_bf16 v[32:47], v[112:115], v[212:215], v[32:47]
    ds_read_b128 v[224:227], v4 offset:25088
    ds_read_b128 v[228:231], v5 offset:25088
    buffer_load_dwordx4 v[148:151], v8, s[4:7], s60 offen offset:1024 sc1
    s_waitcnt vmcnt(7)
    v_permlane16_swap_b32 v120, v122
    v_permlane16_swap_b32 v121, v123
    s_waitcnt lgkmcnt(2)
    v_mfma_f32_32x32x16_bf16 v[16:31], v[216:219], v[116:119], v[16:31]
    v_mfma_f32_32x32x16_bf16 v[32:47], v[116:119], v[220:223], v[32:47]
    ds_read_b128 v[208:211], v4 offset:26880
    ds_read_b128 v[212:215], v5 offset:26880
    buffer_load_dwordx4 v[152:155], v8, s[4:7], s60 offen offset:2048 sc1
    s_waitcnt vmcnt(7)
    v_permlane16_swap_b32 v124, v126
    v_permlane16_swap_b32 v125, v127
    s_waitcnt lgkmcnt(2)
    v_mfma_f32_32x32x16_bf16 v[16:31], v[224:227], v[120:123], v[16:31]
    v_mfma_f32_32x32x16_bf16 v[32:47], v[120:123], v[228:231], v[32:47]
    ds_read_b128 v[216:219], v4 offset:28672
    ds_read_b128 v[220:223], v5 offset:28672
    buffer_load_dwordx4 v[156:159], v8, s[4:7], s60 offen offset:3072 sc1
    s_add_u32 s60, s60, 4096
    s_waitcnt vmcnt(7)
    v_permlane16_swap_b32 v128, v130
    v_permlane16_swap_b32 v129, v131
    s_waitcnt lgkmcnt(2)
    v_mfma_f32_32x32x16_bf16 v[16:31], v[208:211], v[124:127], v[16:31]
    v_mfma_f32_32x32x16_bf16 v[32:47], v[124:127], v[212:215], v[32:47]
    ds_read_b128 v[224:227], v4 offset:30464
    ds_read_b128 v[228:231], v5 offset:30464
    buffer_load_dwordx4 v[160:163], v8, s[4:7], s60 offen offset:0 sc1
    s_waitcnt vmcnt(7)
    v_permlane16_swap_b32 v132, v134
    v_permlane16_swap_b32 v133, v135
    s_waitcnt lgkmcnt(2)
    v_mfma_f32_32x32x16_bf16 v[16:31], v[216:219], v[128:131], v[16:31]
    v_mfma_f32_32x32x16_bf16 v[32:47], v[128:131], v[220:223], v[32:47]
    ds_read_b128 v[208:211], v4 offset:32256
    ds_read_b128 v[212:215], v5 offset:32256
    buffer_load_dwordx4 v[164:167], v8, s[4:7], s60 offen offset:1024 sc1
    s_waitcnt vmcnt(7)
    v_permlane16_swap_b32 v136, v138
    v_permlane16_swap_b32 v137, v139
    s_waitcnt lgkmcnt(2)
    v_mfma_f32_32x32x16_bf16 v[16:31], v[224:227], v[132:135], v[16:31]
    v_mfma_f32_32x32x16_bf16 v[32:47], v[132:135], v[228:231], v[32:47]
    ds_read_b128 v[216:219], v4 offset:34048
    ds_read_b128 v[220:223], v5 offset:34048
    s_setprio 1
    buffer_load_dwordx4 v[168:171], v8, s[4:7], s60 offen offset:2048 sc1
    s_waitcnt vmcnt(7)
    v_permlane16_swap_b32 v140, v142
    v_permlane16_swap_b32 v141, v143
    s_waitcnt lgkmcnt(2)
    v_mfma_f32_32x32x16_bf16 v[16:31], v[208:211], v[136:139], v[16:31]
    v_mfma_f32_32x32x16_bf16 v[32:47], v[136:139], v[212:215], v[32:47]
    ds_read_b128 v[224:227], v4 offset:35840
    ds_read_b128 v[228:231], v5 offset:35840
    buffer_load_dwordx4 v[172:175], v8, s[4:7], s60 offen offset:3072 sc1
    s_add_u32 s60, s60, 4096
    s_waitcnt vmcnt(7)
    v_permlane16_swap_b32 v144, v146
    v_permlane16_swap_b32 v145, v147
    s_waitcnt lgkmcnt(2)
    v_mfma_f32_32x32x16_bf16 v[16:31], v[216:219], v[140:143], v[16:31]
    v_mfma_f32_32x32x16_bf16 v[32:47], v[140:143], v[220:223], v[32:47]
    ds_read_b128 v[208:211], v4 offset:37632
    ds_read_b128 v[212:215], v5 offset:37632
    buffer_load_dwordx4 v[176:179], v8, s[4:7], s60 offen offset:0 sc1
    s_waitcnt vmcnt(7)
    v_permlane16_swap_b32 v148, v150
    v_permlane16_swap_b32 v149, v151
    s_waitcnt lgkmcnt(2)
    v_mfma_f32_32x32x16_bf16 v[16:31], v[224:227], v[144:147], v[16:31]
    v_mfma_f32_32x32x16_bf16 v[32:47], v[144:147], v[228:231], v[32:47]
    ds_read_b128 v[216:219], v4 offset:39424
    ds_read_b128 v[220:223], v5 offset:39424
    buffer_load_dwordx4 v[10:13], v53, s[4:7], s75 offen sc1
    buffer_load_dwordx4 v[180:183], v8, s[4:7], s60 offen offset:1024 sc1
    s_waitcnt vmcnt(7)
    v_permlane16_swap_b32 v152, v154
    v_permlane16_swap_b32 v153, v155
    s_waitcnt lgkmcnt(2)
    v_mfma_f32_32x32x16_bf16 v[16:31], v[208:211], v[148:151], v[16:31]
    v_mfma_f32_32x32x16_bf16 v[32:47], v[148:151], v[212:215], v[32:47]
    ds_read_b128 v[224:227], v4 offset:41216
    ds_read_b128 v[228:231], v5 offset:41216
    buffer_load_dwordx4 v[184:187], v8, s[4:7], s60 offen offset:2048 sc1
    s_waitcnt vmcnt(7)
    v_permlane16_swap_b32 v156, v158
    v_permlane16_swap_b32 v157, v159
    s_waitcnt lgkmcnt(2)
    v_mfma_f32_32x32x16_bf16 v[16:31], v[216:219], v[152:155], v[16:31]
    v_mfma_f32_32x32x16_bf16 v[32:47], v[152:155], v[220:223], v[32:47]
    ds_read_b128 v[208:211], v4 offset:43008
    ds_read_b128 v[212:215], v5 offset:43008
    buffer_load_dwordx4 v[188:191], v8, s[4:7], s60 offen offset:3072 sc1
    s_add_u32 s60, s60, 4096
    s_waitcnt vmcnt(7)
    v_permlane16_swap_b32 v160, v162
    v_permlane16_swap_b32 v161, v163
    s_waitcnt lgkmcnt(2)
    v_mfma_f32_32x32x16_bf16 v[16:31], v[224:227], v[156:159], v[16:31]
    v_mfma_f32_32x32x16_bf16 v[32:47], v[156:159], v[228:231], v[32:47]
    ds_read_b128 v[216:219], v4 offset:44800
    ds_read_b128 v[220:223], v5 offset:44800
    buffer_load_dwordx4 v[192:195], v8, s[4:7], s60 offen offset:0 sc1
    s_waitcnt vmcnt(7)
    v_permlane16_swap_b32 v164, v166
    v_permlane16_swap_b32 v165, v167
    s_waitcnt lgkmcnt(2)
    v_mfma_f32_32x32x16_bf16 v[16:31], v[208:211], v[160:163], v[16:31]
    v_mfma_f32_32x32x16_bf16 v[32:47], v[160:163], v[212:215], v[32:47]
    ds_read_b128 v[224:227], v4 offset:46592
    ds_read_b128 v[228:231], v5 offset:46592
    buffer_load_dwordx4 v[196:199], v8, s[4:7], s60 offen offset:1024 sc1
    s_waitcnt vmcnt(7)
    v_permlane16_swap_b32 v168, v170
    v_permlane16_swap_b32 v169, v171
    s_waitcnt lgkmcnt(2)
    v_mfma_f32_32x32x16_bf16 v[16:31], v[216:219], v[164:167], v[16:31]
    v_mfma_f32_32x32x16_bf16 v[32:47], v[164:167], v[220:223], v[32:47]
    ds_read_b128 v[208:211], v4 offset:48384
    ds_read_b128 v[212:215], v5 offset:48384
    buffer_load_dwordx4 v[200:203], v8, s[4:7], s60 offen offset:2048 sc1
    s_waitcnt vmcnt(7)
    v_permlane16_swap_b32 v172, v174
    v_permlane16_swap_b32 v173, v175
    s_waitcnt lgkmcnt(2)
    v_mfma_f32_32x32x16_bf16 v[16:31], v[224:227], v[168:171], v[16:31]
    v_mfma_f32_32x32x16_bf16 v[32:47], v[168:171], v[228:231], v[32:47]
    ds_read_b128 v[216:219], v4 offset:50176
    ds_read_b128 v[220:223], v5 offset:50176
    s_setprio 0
    buffer_load_dwordx4 v[204:207], v8, s[4:7], s60 offen offset:3072 sc1
    s_waitcnt vmcnt(7)
    v_permlane16_swap_b32 v176, v178
    v_permlane16_swap_b32 v177, v179
    s_waitcnt lgkmcnt(2)
    v_mfma_f32_32x32x16_bf16 v[16:31], v[208:211], v[172:175], v[16:31]
    v_mfma_f32_32x32x16_bf16 v[32:47], v[172:175], v[212:215], v[32:47]
    ds_read_b128 v[224:227], v4 offset:51968
    ds_read_b128 v[228:231], v5 offset:51968
    s_waitcnt vmcnt(6)
    v_permlane16_swap_b32 v180, v182
    v_permlane16_swap_b32 v181, v183
    s_waitcnt lgkmcnt(2)
    v_mfma_f32_32x32x16_bf16 v[16:31], v[216:219], v[176:179], v[16:31]
    v_mfma_f32_32x32x16_bf16 v[32:47], v[176:179], v[220:223], v[32:47]
    ds_read_b128 v[208:211], v4 offset:53760
    ds_read_b128 v[212:215], v5 offset:53760
    s_waitcnt vmcnt(5)
    v_permlane16_swap_b32 v184, v186
    v_permlane16_swap_b32 v185, v187
    s_waitcnt lgkmcnt(2)
    v_mfma_f32_32x32x16_bf16 v[16:31], v[224:227], v[180:183], v[16:31]
    v_mfma_f32_32x32x16_bf16 v[32:47], v[180:183], v[228:231], v[32:47]
    ds_read_b128 v[216:219], v4 offset:55552
    ds_read_b128 v[220:223], v5 offset:55552
    s_waitcnt vmcnt(4)
    v_permlane16_swap_b32 v188, v190
    v_permlane16_swap_b32 v189, v191
    s_waitcnt lgkmcnt(2)
    v_mfma_f32_32x32x16_bf16 v[16:31], v[208:211], v[184:187], v[16:31]
    v_mfma_f32_32x32x16_bf16 v[32:47], v[184:187], v[212:215], v[32:47]
    ds_read_b128 v[224:227], v4 offset:57344
    ds_read_b128 v[228:231], v5 offset:57344
    s_waitcnt vmcnt(3)
    v_permlane16_swap_b32 v192, v194
    v_permlane16_swap_b32 v193, v195
    s_waitcnt lgkmcnt(2)
    v_mfma_f32_32x32x16_bf16 v[16:31], v[216:219], v[188:191], v[16:31]
    v_mfma_f32_32x32x16_bf16 v[32:47], v[188:191], v[220:223], v[32:47]
    ds_read_b128 v[208:211], v4 offset:59136
    ds_read_b128 v[212:215], v5 offset:59136
    s_mov_b32 s96, 400000
Ls_27:
    v_cmp_eq_u64 vcc, s[28:29], v[12:13]
    s_nop 0
    s_cmp_eq_u64 vcc, exec
    s_cbranch_scc1 Lsd_28
    buffer_load_dwordx4 v[10:13], v53, s[4:7], s75 offen sc1
    s_sub_u32 s96, s96, 1
    s_cmp_lg_u32 s96, 0
    s_waitcnt vmcnt(0)
    s_cbranch_scc1 Ls_27
    v_mov_b32 v12, 9
    v_mov_b32 v13, 0
    global_store_dword v13, v12, s[52:53]
    s_waitcnt vmcnt(0)
Lsd_28:
    v_mul_f32 v12, 0x3eae1a93, v11
    ds_write_b32 v60, v11
    ds_write_b32 v60, v12 offset:128
    ds_read_b128 v[96:99], v61 offset:0
    ds_read_b128 v[100:103], v61 offset:32
    ds_read_b128 v[104:107], v61 offset:64
    ds_read_b128 v[108:111], v61 offset:96
    s_mov_b32 s62, -1
    s_mov_b32 s63, 0
    v_cndmask_b32 v10, 0, v10, s[62:63]
    v_and_b32 v13, s64, v10
    v_sub_f32 v14, v10, v13
    v_cvt_pk_bf16_f32 v14, v13, v14
    v_cvt_pk_bf16_f32 v15, v13, 0
    s_waitcnt vmcnt(2)
    v_permlane16_swap_b32 v196, v198
    v_permlane16_swap_b32 v197, v199
    s_waitcnt lgkmcnt(2)
    v_mfma_f32_32x32x16_bf16 v[16:31], v[224:227], v[192:195], v[16:31]
    v_mfma_f32_32x32x16_bf16 v[32:47], v[192:195], v[228:231], v[32:47]
    ds_read_b128 v[216:219], v4 offset:60928
    ds_read_b128 v[220:223], v5 offset:60928
    s_waitcnt vmcnt(1)
    v_permlane16_swap_b32 v200, v202
    v_permlane16_swap_b32 v201, v203
    s_waitcnt lgkmcnt(2)
    v_mfma_f32_32x32x16_bf16 v[16:31], v[208:211], v[196:199], v[16:31]
    v_mfma_f32_32x32x16_bf16 v[32:47], v[196:199], v[212:215], v[32:47]
    ds_read_b128 v[224:227], v4 offset:62720
    ds_read_b128 v[228:231], v5 offset:62720
    s_waitcnt vmcnt(0)
    v_permlane16_swap_b32 v204, v206
    v_permlane16_swap_b32 v205, v207
    s_waitcnt lgkmcnt(2)
    v_mfma_f32_32x32x16_bf16 v[16:31], v[216:219], v[200:203], v[16:31]
    v_mfma_f32_32x32x16_bf16 v[32:47], v[200:203], v[220:223], v[32:47]
    s_waitcnt lgkmcnt(0)
    v_mfma_f32_32x32x16_bf16 v[16:31], v[224:227], v[204:207], v[16:31]
    v_mfma_f32_32x32x16_bf16 v[32:47], v[204:207], v[228:231], v[32:47]
    s_mov_b32 s62, 0xfffff
    s_mov_b32 s63, 0xfffff
    v_mfma_f32_32x32x8bf16_1k v[32:47], v[14:15], v[252:253], v[32:47]
    v_mfma_f32_32x32x8bf16_1k v[16:31], v[250:251], v[14:15], v[16:31]
    s_mov_b32 s66, 0xf00000
    s_mov_b32 s67, 0xf00000
    v_mov_b32 v192, 0
    v_mov_b32 v193, 0
    v_mov_b32 v194, 0
    v_mov_b32 v195, 0
    v_mov_b32 v196, 0
    v_mov_b32 v197, 0
    v_mov_b32 v198, 0
    v_mov_b32 v199, 0
    v_mov_b32 v200, 0
    v_mov_b32 v201, 0
    v_mov_b32 v202, 0
    v_mov_b32 v203, 0
    v_mov_b32 v204, 0
    v_mov_b32 v205, 0
    v_mov_b32 v206, 0
    v_mov_b32 v207, 0
    s_waitcnt lgkmcnt(0)
    v_mul_f32 v32, v96, v32
    v_mul_f32 v33, v97, v33
    v_mul_f32 v34, v98, v34
    v_mul_f32 v35, v99, v35
    v_mul_f32 v36, v100, v36
    v_mul_f32 v37, v101, v37
    v_mul_f32 v38, v102, v38
    v_mul_f32 v39, v103, v39
    v_mul_f32 v40, v104, v40
    v_mul_f32 v41, v105, v41
    v_mul_f32 v42, v106, v42
    v_mul_f32 v43, v107, v43
    v_mul_f32 v44, v108, v44
    v_mul_f32 v45, v109, v45
    v_mul_f32 v46, v110, v46
    v_mul_f32 v47, v111, v47
    v_cvt_pk_bf16_f32 v120, v32, v33
    v_cvt_pk_bf16_f32 v121, v34, v35
    v_cvt_pk_bf16_f32 v122, v36, v37
    v_cvt_pk_bf16_f32 v123, v38, v39
    v_cvt_pk_bf16_f32 v124, v40, v41
    v_cvt_pk_bf16_f32 v125, v42, v43
    v_cvt_pk_bf16_f32 v126, v44, v45
    v_cvt_pk_bf16_f32 v127, v46, v47
    s_mov_b64 exec, s[66:67]
    ds_write_b16 v57, v120 offset:0
    ds_write_b16_d16_hi v57, v120 offset:4
    ds_write_b16 v57, v121 offset:8
    ds_write_b16_d16_hi v57, v121 offset:12
    ds_write_b16 v57, v122 offset:16
    ds_write_b16_d16_hi v57, v122 offset:20
    ds_write_b16 v57, v123 offset:24
    ds_write_b16_d16_hi v57, v123 offset:28
    ds_write_b16 v57, v124 offset:64
    ds_write_b16_d16_hi v57, v124 offset:68
    ds_write_b16 v57, v125 offset:72
    ds_write_b16_d16_hi v57, v125 offset:76
    ds_write_b16 v57, v126 offset:80
    ds_write_b16_d16_hi v57, v126 offset:84
    ds_write_b16 v57, v127 offset:88
    ds_write_b16_d16_hi v57, v127 offset:92
    s_mov_b64 exec, -1
    ds_read_b32 v63, v59
    ds_read_b32 v212, v58
    s_mov_b32 s66, 0xc0000
    s_mov_b32 s67, 0xc0000
    v_cndmask_b32 v120, v120, v62, s[66:67]
    v_cndmask_b32 v121, v121, v62, s[66:67]
    v_cndmask_b32 v122, v122, v62, s[66:67]
    v_cndmask_b32 v123, v123, v62, s[66:67]
    v_cndmask_b32 v124, v124, v62, s[66:67]
    v_cndmask_b32 v125, v125, v62, s[66:67]
    v_cndmask_b32 v126, v126, v62, s[66:67]
    v_cndmask_b32 v127, v127, v62, s[66:67]
    s_mov_b64 exec, s[62:63]
    buffer_store_dwordx4 v[120:123], v55, s[4:7], s89 offen sc1
    buffer_store_dwordx4 v[124:127], v55, s[4:7], s89 offen offset:640 sc1
    s_mov_b64 exec, -1
    v_mul_f32 v24, v11, v24
    v_mul_f32 v25, v11, v25
    v_mul_f32 v26, v11, v26
    v_mul_f32 v27, v11, v27
    v_mul_f32 v28, v11, v28
    v_mul_f32 v29, v11, v29
    v_mul_f32 v30, v11, v30
    v_mul_f32 v31, v11, v31
    v_cvt_pk_bf16_f32 v112, v24, v25
    v_cvt_pk_bf16_f32 v113, v26, v27
    v_cvt_pk_bf16_f32 v114, v28, v29
    v_cvt_pk_bf16_f32 v115, v30, v31
    buffer_store_dwordx4 v[112:115], v54, s[4:7], s89 offen sc1
    s_waitcnt lgkmcnt(0)
    s_mov_b32 exec_hi, 0
    buffer_store_dword v63, v59, s[4:7], s89 offen sc1
    s_mov_b64 exec, s[62:63]
    ds_write_b128 v55, v[120:123] offset:0
    ds_write_b128 v55, v[124:127] offset:640
    s_mov_b64 exec, -1
    ds_write_b128 v54, v[112:115] offset:0
    v_mul_f32 v16, v12, v16
    v_mul_f32 v17, v12, v17
    v_mul_f32 v18, v12, v18
    v_mul_f32 v19, v12, v19
    v_mul_f32 v20, v12, v20
    v_mul_f32 v21, v12, v21
    v_mul_f32 v22, v12, v22
    v_mul_f32 v23, v12, v23
    v_cvt_pk_bf16_f32 v208, v16, v17
    v_cvt_pk_bf16_f32 v209, v18, v19
    v_cvt_pk_bf16_f32 v210, v20, v21
    v_cvt_pk_bf16_f32 v211, v22, v23
    v_mov_b32 v217, v56
    s_waitcnt lgkmcnt(0)
    v_lshlrev_b32 v218, 4, v2
    v_lshlrev_b32 v219, 2, v2
    v_mov_b32 v220, v217
    v_add_u32 v215, 37632, v218
    v_add_u32 v216, 37632, v219
    v_add_u32 v217, 37632, v220
    v_mov_b32 v214, 0xdddddddd
    v_mov_b32 v213, 0
    v_mov_b32 v25, 0
    v_mov_b32 v27, 0
    s_add_u32 s70, s69, s24
    s_lshl_b32 s70, s70, 3
    s_add_u32 s70, s70, s26
    s_lshl_b32 s70, s70, 6
    s_add_u32 s70, s70, 73728
    s_lshl_b32 s83, s26, 10
    s_and_b32 s84, s25, 7
    s_mul_i32 s84, s84, 82944
    s_add_u32 s84, s84, 7340032
    s_add_u32 s84, s84, s83
    v_mov_b32 v222, s28
    v_mov_b32 v223, s29
    v_mov_b32 v224, 0
    s_barrier
    ds_read_b32 v24, v219 offset:18432
    ds_read_b128 v[8:11], v218 offset:0
    ds_read_b128 v[12:15], v218 offset:1024
    ds_read_b128 v[28:31], v220 offset:8192
    ds_read_b128 v[32:35], v220 offset:8832
    ds_read_b32 v26, v219 offset:18688
    ds_read_b128 v[16:19], v218 offset:2048
    ds_read_b128 v[36:39], v220 offset:9472
    ds_read_b128 v[20:23], v218 offset:3072
    ds_read_b128 v[40:43], v220 offset:10112
    s_cmp_lt_u32 s26, 4
    s_cbranch_scc1 L_29
    s_waitcnt vmcnt(0)
    s_mov_b64 exec, 1
    buffer_store_dwordx2 v[222:223], v224, s[4:7], s70 offen sc1
    s_mov_b64 exec, -1
    s_cmp_lg_u32 s27, 0
    s_cbranch_scc1 L_29
    s_cmp_ge_u32 s25, 18
    s_cbranch_scc1 L_29
    buffer_store_dwordx2 v[232:233], v248, s[4:7], s79 offen sc1
    s_add_u32 s79, s79, 73728
    buffer_store_dwordx2 v[234:235], v248, s[4:7], s79 offen sc1
    s_add_u32 s79, s79, 73728
    buffer_store_dwordx2 v[236:237], v248, s[4:7], s79 offen sc1
    s_add_u32 s79, s79, 73728
    buffer_store_dwordx2 v[238:239], v248, s[4:7], s79 offen sc1
    s_add_u32 s79, s79, 73728
    buffer_store_dwordx2 v[240:241], v248, s[4:7], s79 offen sc1
    s_add_u32 s79, s79, 73728
    buffer_store_dwordx2 v[242:243], v248, s[4:7], s79 offen sc1
    s_add_u32 s79, s79, 73728
    buffer_store_dwordx2 v[244:245], v248, s[4:7], s79 offen sc1
    s_add_u32 s79, s79, 73728
    buffer_store_dwordx2 v[246:247], v248, s[4:7], s79 offen sc1
    s_add_u32 s79, s79, 73728
L_29:
    s_waitcnt lgkmcnt(7)
    v_mfma_f32_32x32x4bf16_1k v[128:159], v[24:25], v[212:213], 0
    s_nop 15
    s_nop 1
    v_mfma_f32_32x32x16_bf16 v[128:143], v[8:11], v[208:211], v[128:143]
    v_mfma_f32_32x32x16_bf16 v[144:159], v[12:15], v[208:211], v[144:159]
    s_nop 10
    v_exp_f32 v128, v128
    v_exp_f32 v129, v129
    ds_read_b32 v24, v219 offset:18944
    v_exp_f32 v130, v130
    v_exp_f32 v131, v131
    v_exp_f32 v132, v132
    s_waitcnt lgkmcnt(4)
    v_mfma_f32_32x32x4bf16_1k v[160:191], v[26:27], v[212:213], 0
    ds_read_b128 v[44:47], v220 offset:10752
    v_exp_f32 v133, v133
    v_exp_f32 v134, v134
    v_exp_f32 v135, v135
    v_exp_f32 v136, v136
    v_exp_f32 v137, v137
    v_exp_f32 v138, v138
    v_exp_f32 v139, v139
    v_exp_f32 v140, v140
    v_smfmac_f32_32x32x32_bf16 v[192:207], v[28:31], v[128:135], v214
    ds_read_b128 v[48:51], v220 offset:11392
    v_exp_f32 v141, v141
    v_exp_f32 v142, v142
    v_exp_f32 v143, v143
    v_exp_f32 v144, v144
    v_exp_f32 v145, v145
    v_smfmac_f32_32x32x32_bf16 v[192:207], v[32:35], v[136:143], v214
    ds_read_b128 v[8:11], v218 offset:4096
    v_exp_f32 v146, v146
    v_exp_f32 v147, v147
    v_exp_f32 v148, v148
    v_exp_f32 v149, v149
    v_mfma_f32_32x32x16_bf16 v[160:175], v[16:19], v[208:211], v[160:175]
    ds_read_b128 v[52:55], v220 offset:12032
    v_exp_f32 v150, v150
    v_exp_f32 v151, v151
    v_exp_f32 v152, v152
    v_exp_f32 v153, v153
    s_waitcnt lgkmcnt(5)
    v_smfmac_f32_32x32x32_bf16 v[192:207], v[36:39], v[144:151], v214
    ds_read_b128 v[12:15], v218 offset:5120
    v_exp_f32 v154, v154
    v_exp_f32 v155, v155
    v_exp_f32 v156, v156
    v_mfma_f32_32x32x16_bf16 v[176:191], v[20:23], v[208:211], v[176:191]
    ds_read_b128 v[56:59], v220 offset:12672
    v_exp_f32 v157, v157
    v_exp_f32 v158, v158
    v_exp_f32 v159, v159
    s_cmp_ge_u32 s26, 4
    s_cbranch_scc1 L_30
    s_waitcnt vmcnt(0)
    s_mov_b64 exec, 1
    buffer_store_dwordx2 v[222:223], v224, s[4:7], s70 offen sc1
    s_mov_b64 exec, -1
L_30:
    v_exp_f32 v160, v160
    v_exp_f32 v161, v161
    v_smfmac_f32_32x32x32_bf16 v[192:207], v[40:43], v[152:159], v214
    ds_read_b32 v26, v219 offset:19200
    v_exp_f32 v162, v162
    v_exp_f32 v163, v163
    v_exp_f32 v164, v164
    s_waitcnt lgkmcnt(4)
    v_mfma_f32_32x32x4bf16_1k v[128:159], v[24:25], v[212:213], 0
    ds_read_b128 v[28:31], v220 offset:13312
    v_exp_f32 v165, v165
    v_exp_f32 v166, v166
    v_exp_f32 v167, v167
    v_exp_f32 v168, v168
    v_exp_f32 v169, v169
    v_exp_f32 v170, v170
    v_exp_f32 v171, v171
    v_exp_f32 v172, v172
    v_smfmac_f32_32x32x32_bf16 v[192:207], v[44:47], v[160:167], v214
    ds_read_b128 v[32:35], v220 offset:13952
    v_exp_f32 v173, v173
    v_exp_f32 v174, v174
    v_exp_f32 v175, v175
    v_exp_f32 v176, v176
    v_exp_f32 v177, v177
    v_smfmac_f32_32x32x32_bf16 v[192:207], v[48:51], v[168:175], v214
    ds_read_b128 v[16:19], v218 offset:6144
    v_exp_f32 v178, v178
    v_exp_f32 v179, v179
    v_exp_f32 v180, v180
    v_exp_f32 v181, v181
    v_mfma_f32_32x32x16_bf16 v[128:143], v[8:11], v[208:211], v[128:143]
    ds_read_b128 v[36:39], v220 offset:14592
    v_exp_f32 v182, v182
    v_exp_f32 v183, v183
    v_exp_f32 v184, v184
    v_exp_f32 v185, v185
    s_waitcnt lgkmcnt(5)
    v_smfmac_f32_32x32x32_bf16 v[192:207], v[52:55], v[176:183], v214
    ds_read_b128 v[20:23], v218 offset:7168
    v_exp_f32 v186, v186
    v_exp_f32 v187, v187
    v_exp_f32 v188, v188
    v_mfma_f32_32x32x16_bf16 v[144:159], v[12:15], v[208:211], v[144:159]
    ds_read_b128 v[40:43], v220 offset:15232
    v_exp_f32 v189, v189
    v_exp_f32 v190, v190
    v_exp_f32 v191, v191
    s_cmp_lg_u32 s26, 0
    s_cbranch_scc1 L_31
    s_mov_b32 s62, 0
    s_lshl_b32 s61, s69, 9
    s_add_u32 s61, s61, 73728
    s_add_u32 s60, s24, 1
    s_lshl_b32 s60, s60, 3
    v_add_u32 v4, s60, v2
    v_and_b32 v4, 63, v4
    v_lshlrev_b32 v4, 6, v4
    s_mov_b64 exec, 0xffff
    buffer_load_dwordx2 v[6:7], v4, s[4:7], s61 offen sc1
    s_mov_b64 exec, -1
L_31:
    v_exp_f32 v128, v128
    v_exp_f32 v129, v129
    v_smfmac_f32_32x32x32_bf16 v[192:207], v[56:59], v[184:191], v214
    v_exp_f32 v130, v130
    v_exp_f32 v131, v131
    v_exp_f32 v132, v132
    s_waitcnt lgkmcnt(3)
    v_mfma_f32_32x32x4bf16_1k v[160:191], v[26:27], v[212:213], 0
    ds_read_b128 v[44:47], v220 offset:15872
    v_exp_f32 v133, v133
    v_exp_f32 v134, v134
    v_exp_f32 v135, v135
    v_exp_f32 v136, v136
    v_exp_f32 v137, v137
    v_exp_f32 v138, v138
    v_exp_f32 v139, v139
    v_exp_f32 v140, v140
    v_smfmac_f32_32x32x32_bf16 v[192:207], v[28:31], v[128:135], v214
    ds_read_b128 v[48:51], v220 offset:16512
    v_exp_f32 v141, v141
    v_exp_f32 v142, v142
    v_exp_f32 v143, v143
    v_exp_f32 v144, v144
    v_exp_f32 v145, v145
    v_smfmac_f32_32x32x32_bf16 v[192:207], v[32:35], v[136:143], v214
    v_exp_f32 v146, v146
    v_exp_f32 v147, v147
    v_exp_f32 v148, v148
    v_exp_f32 v149, v149
    v_mfma_f32_32x32x16_bf16 v[160:175], v[16:19], v[208:211], v[160:175]
    ds_read_b128 v[52:55], v220 offset:17152
    v_exp_f32 v150, v150
    v_exp_f32 v151, v151
    v_exp_f32 v152, v152
    v_exp_f32 v153, v153
    s_waitcnt lgkmcnt(3)
    v_smfmac_f32_32x32x32_bf16 v[192:207], v[36:39], v[144:151], v214
    v_exp_f32 v154, v154
    v_exp_f32 v155, v155
    v_exp_f32 v156, v156
    v_mfma_f32_32x32x16_bf16 v[176:191], v[20:23], v[208:211], v[176:191]
    ds_read_b128 v[56:59], v220 offset:17792
    v_exp_f32 v157, v157
    v_exp_f32 v158, v158
    v_exp_f32 v159, v159
    s_cmp_lg_u32 s26, 0
    s_cbranch_scc1 L_32
    s_cmp_ge_u32 s62, 2
    s_cbranch_scc1 L_32
    s_call_b64 s[76:77], L_try
L_32:
    v_exp_f32 v160, v160
    v_exp_f32 v161, v161
    v_smfmac_f32_32x32x32_bf16 v[192:207], v[40:43], v[152:159], v214
    v_exp_f32 v162, v162
    v_exp_f32 v163, v163
    v_exp_f32 v164, v164
    s_waitcnt lgkmcnt(2)
    v_exp_f32 v165, v165
    v_exp_f32 v166, v166
    v_exp_f32 v167, v167
    v_exp_f32 v168, v168
    v_exp_f32 v169, v169
    v_exp_f32 v170, v170
    v_exp_f32 v171, v171
    v_exp_f32 v172, v172
    v_smfmac_f32_32x32x32_bf16 v[192:207], v[44:47], v[160:167], v214
    v_exp_f32 v173, v173
    v_exp_f32 v174, v174
    v_exp_f32 v175, v175
    v_exp_f32 v176, v176
    v_exp_f32 v177, v177
    v_smfmac_f32_32x32x32_bf16 v[192:207], v[48:51], v[168:175], v214
    v_exp_f32 v178, v178
    v_exp_f32 v179, v179
    v_exp_f32 v180, v180
    v_exp_f32 v181, v181
    v_exp_f32 v182, v182
    v_exp_f32 v183, v183
    v_exp_f32 v184, v184
    v_exp_f32 v185, v185
    s_waitcnt lgkmcnt(0)
    v_smfmac_f32_32x32x32_bf16 v[192:207], v[52:55], v[176:183], v214
    v_exp_f32 v186, v186
    v_exp_f32 v187, v187
    v_exp_f32 v188, v188
    v_exp_f32 v189, v189
    v_exp_f32 v190, v190
    v_exp_f32 v191, v191
    s_nop 1
    v_smfmac_f32_32x32x32_bf16 v[192:207], v[56:59], v[184:191], v214
    s_cmp_lg_u32 s26, 0
    s_cbranch_scc1 L_34
    s_mov_b32 s96, 400000
L_35:
    s_cmp_ge_u32 s62, 1
    s_cbranch_scc1 L_36
    s_call_b64 s[76:77], L_try
    s_sub_u32 s96, s96, 1
    s_cmp_lg_u32 s96, 0
    s_cbranch_scc1 L_35
    v_mov_b32 v228, 5
    v_mov_b32 v229, 0
    global_store_dword v229, v228, s[52:53]
    s_waitcnt vmcnt(0)
L_36:
L_34:
    v_lshrrev_b32 v61, 5, v2
    v_and_b32 v60, 15, v2
    v_lshlrev_b32 v226, 1, v60
    v_bfe_u32 v225, v2, 4, 1
    v_add_u32 v226, v226, v225
    s_lshl_b32 s60, s30, 5
    v_add_u32 v226, s60, v226
    v_lshlrev_b32 v225, 4, v226
    v_lshl_add_u32 v225, v61, 12, v225
    v_lshlrev_b32 v226, 2, v226
    s_lshl_b32 s60, s27, 3
    s_add_u32 s60, s60, s24
    s_lshl_b32 s71, s60, 5
    s_add_u32 s60, s71, s25
    s_lshl_b32 s81, s60, 13
    s_add_u32 s81, s81, 28311552
    s_lshl_b32 s82, s60, 10
    s_add_u32 s82, s82, 32505856
    s_cmp_ge_u32 s26, 4
    s_cbranch_scc1 L_37
    v_lshrrev_b32 v61, 4, v2
    s_lshr_b32 s64, s25, 3
    s_and_b32 s65, s25, 7
    s_lshl_b32 s66, s64, 6
    s_lshl_b32 s67, s31, 4
    s_add_u32 s66, s66, s67
    v_add_u32 v62, s66, v60
    v_lshlrev_b32 v64, 8, v61
    v_lshl_add_u32 v64, v60, 3, v64
    v_lshl_add_u32 v63, v61, 8, v64
    v_add_u32 v64, 4096, v64
    v_mov_b32 v65, 0x7fffffff
    v_cmp_gt_u32 vcc, 2, v61
    s_mul_i32 s60, s65, 4608
    s_lshl_b32 s63, s24, 3
    s_lshr_b32 s67, s66, 5
    s_add_u32 s63, s63, s67
    s_mul_i32 s63, s63, 36864
    s_add_u32 s60, s60, s63
    s_and_b32 s63, s66, 16
    s_lshl_b32 s63, s63, 3
    s_add_u32 s67, s60, s63
    v_cndmask_b32 v64, v65, v64, vcc
    v_lshrrev_b32 v65, 1, v61
    v_lshlrev_b32 v65, 13, v65
    v_and_b32 v66, 1, v61
    v_lshl_add_u32 v65, v66, 12, v65
    v_lshl_add_u32 v65, v62, 4, v65
    v_lshlrev_b32 v66, 12, v61
    v_lshl_add_u32 v66, v62, 2, v66
    v_lshlrev_b32 v67, 4, v2
    v_and_b32 v68, 7, v2
    v_lshlrev_b32 v68, 4, v68
    v_lshl_add_u32 v68, v61, 7, v68
    v_add_u32 v68, 4096, v68
    v_add_u32 v69, 41472, v67
    v_add_u32 v70, 41472, v68
    v_and_b32 v71, 31, v2
    v_lshlrev_b32 v71, 6, v71
    v_min_u32 v72, 17, v2
    v_lshlrev_b32 v72, 8, v72
    s_mul_i32 s78, s65, 4608
    s_lshr_b32 s63, s24, 1
    s_lshl_b32 s63, s63, 6
    s_add_u32 s78, s78, s63
    s_add_u32 s78, s78, 1114112
L_37:
    s_cmp_lg_u32 s26, 0
    s_cbranch_scc1 L_33
    s_cmp_lg_u32 s62, 2
    s_cbranch_scc1 L_33
    s_waitcnt vmcnt(19)
    s_branch L_38
L_33:
    s_waitcnt vmcnt(0)
L_38:
    s_barrier
    ds_read_b32 v24, v216 offset:57344
    ds_read_b128 v[8:11], v215 offset:38912
    ds_read_b128 v[12:15], v215 offset:39936
    ds_read_b128 v[28:31], v217 offset:47104
    ds_read_b128 v[32:35], v217 offset:47744
    ds_read_b32 v26, v216 offset:57600
    ds_read_b128 v[16:19], v215 offset:40960
    ds_read_b128 v[36:39], v217 offset:48384
    ds_read_b128 v[20:23], v215 offset:41984
    ds_read_b128 v[40:43], v217 offset:49024
    s_cmp_lg_u32 s26, 0
    s_cbranch_scc1 L_39
    s_setprio 3
    s_mov_b32 s96, 400000
L_41:
    s_cmp_ge_u32 s62, 2
    s_cbranch_scc1 L_42
    s_call_b64 s[76:77], L_try
    s_sub_u32 s96, s96, 1
    s_cmp_lg_u32 s96, 0
    s_cbranch_scc1 L_41
    v_mov_b32 v228, 5
    v_mov_b32 v229, 0
    global_store_dword v229, v228, s[52:53]
    s_waitcnt vmcnt(0)
L_42:
L_39:
    s_cmp_lt_u32 s26, 4
    s_cbranch_scc1 L_43
    s_cmp_lg_u32 s27, 0
    s_cbranch_scc1 L_43
    s_cmp_ge_u32 s25, 18
    s_cbranch_scc1 L_43
    s_mov_b64 exec, 1
    buffer_store_dwordx2 v[222:223], v224, s[4:7], s80 offen sc1
    s_mov_b64 exec, -1
L_43:
    s_cmp_lg_u32 s26, 6
    s_cbranch_scc1 L_44
    s_setprio 3
    s_lshl_b32 s61, s69, 9
    s_add_u32 s61, s61, 73728
    v_lshlrev_b32 v4, 6, v2
    v_min_u32 v5, 17, v2
    v_lshlrev_b32 v5, 6, v5
    s_mov_b32 s60, 25088
    s_mov_b32 s96, 400000
Lpoll_45:
    buffer_load_dwordx2 v[60:61], v4, s[4:7], s61 offen offset:0 sc1
    buffer_load_dwordx2 v[62:63], v5, s[4:7], s60 offen offset:0 sc1
    s_waitcnt vmcnt(0)
    v_cmp_ne_u64 vcc, s[28:29], v[60:61]
    v_cmp_ne_u64 s[94:95], s[28:29], v[62:63]
    s_nop 0
    s_or_b64 vcc, vcc, s[94:95]
    s_cmp_eq_u64 vcc, 0
    s_cbranch_scc1 Lpolld_46
    s_mov_b64 exec, vcc
    s_sleep 1
    s_sub_u32 s96, s96, 1
    s_cmp_lg_u32 s96, 0
    s_cbranch_scc1 Lpoll_45
    v_mov_b32 v60, 5
    v_mov_b32 v61, 0
    global_store_dword v61, v60, s[52:53]
    s_waitcnt vmcnt(0)
Lpolld_46:
    s_mov_b64 exec, -1
L_44:
    s_waitcnt lgkmcnt(7)
    v_mfma_f32_32x32x4bf16_1k v[128:159], v[24:25], v[212:213], 0
    s_nop 15
    s_nop 1
    v_mfma_f32_32x32x16_bf16 v[128:143], v[8:11], v[208:211], v[128:143]
    v_mfma_f32_32x32x16_bf16 v[144:159], v[12:15], v[208:211], v[144:159]
    s_nop 10
    s_setprio 1
    v_exp_f32 v128, v128
    v_exp_f32 v129, v129
    ds_read_b32 v24, v216 offset:57856
    v_exp_f32 v130, v130
    v_exp_f32 v131, v131
    v_exp_f32 v132, v132
    s_waitcnt lgkmcnt(4)
    v_mfma_f32_32x32x4bf16_1k v[160:191], v[26:27], v[212:213], 0
    ds_read_b128 v[44:47], v217 offset:49664
    v_exp_f32 v133, v133
    v_exp_f32 v134, v134
    v_exp_f32 v135, v135
    v_exp_f32 v136, v136
    v_exp_f32 v137, v137
    v_exp_f32 v138, v138
    v_exp_f32 v139, v139
    v_exp_f32 v140, v140
    v_smfmac_f32_32x32x32_bf16 v[192:207], v[28:31], v[128:135], v214
    ds_read_b128 v[48:51], v217 offset:50304
    v_exp_f32 v141, v141
    v_exp_f32 v142, v142
    v_exp_f32 v143, v143
    v_exp_f32 v144, v144
    v_exp_f32 v145, v145
    v_smfmac_f32_32x32x32_bf16 v[192:207], v[32:35], v[136:143], v214
    ds_read_b128 v[8:11], v215 offset:43008
    v_exp_f32 v146, v146
    v_exp_f32 v147, v147
    v_exp_f32 v148, v148
    v_exp_f32 v149, v149
    v_mfma_f32_32x32x16_bf16 v[160:175], v[16:19], v[208:211], v[160:175]
    ds_read_b128 v[52:55], v217 offset:50944
    v_exp_f32 v150, v150
    v_exp_f32 v151, v151
    v_exp_f32 v152, v152
    v_exp_f32 v153, v153
    s_waitcnt lgkmcnt(5)
    v_smfmac_f32_32x32x32_bf16 v[192:207], v[36:39], v[144:151], v214
    ds_read_b128 v[12:15], v215 offset:44032
    v_exp_f32 v154, v154
    v_exp_f32 v155, v155
    v_exp_f32 v156, v156
    v_mfma_f32_32x32x16_bf16 v[176:191], v[20:23], v[208:211], v[176:191]
    ds_read_b128 v[56:59], v217 offset:51584
    v_exp_f32 v157, v157
    v_exp_f32 v158, v158
    v_exp_f32 v159, v159
    s_setprio 0
    v_exp_f32 v160, v160
    v_exp_f32 v161, v161
    v_smfmac_f32_32x32x32_bf16 v[192:207], v[40:43], v[152:159], v214
    ds_read_b32 v26, v216 offset:58112
    v_exp_f32 v162, v162
    v_exp_f32 v163, v163
    v_exp_f32 v164, v164
    s_waitcnt lgkmcnt(4)
    v_mfma_f32_32x32x4bf16_1k v[128:159], v[24:25], v[212:213], 0
    ds_read_b128 v[28:31], v217 offset:52224
    v_exp_f32 v165, v165
    v_exp_f32 v166, v166
    v_exp_f32 v167, v167
    v_exp_f32 v168, v168
    v_exp_f32 v169, v169
    v_exp_f32 v170, v170
    v_exp_f32 v171, v171
    v_exp_f32 v172, v172
    v_smfmac_f32_32x32x32_bf16 v[192:207], v[44:47], v[160:167], v214
    ds_read_b128 v[32:35], v217 offset:52864
    v_exp_f32 v173, v173
    v_exp_f32 v174, v174
    v_exp_f32 v175, v175
    v_exp_f32 v176, v176
    v_exp_f32 v177, v177
    v_smfmac_f32_32x32x32_bf16 v[192:207], v[48:51], v[168:175], v214
    ds_read_b128 v[16:19], v215 offset:45056
    v_exp_f32 v178, v178
    v_exp_f32 v179, v179
    v_exp_f32 v180, v180
    v_exp_f32 v181, v181
    v_mfma_f32_32x32x16_bf16 v[128:143], v[8:11], v[208:211], v[128:143]
    ds_read_b128 v[36:39], v217 offset:53504
    v_exp_f32 v182, v182
    v_exp_f32 v183, v183
    v_exp_f32 v184, v184
    v_exp_f32 v185, v185
    s_waitcnt lgkmcnt(5)
    v_smfmac_f32_32x32x32_bf16 v[192:207], v[52:55], v[176:183], v214
    ds_read_b128 v[20:23], v215 offset:46080
    v_exp_f32 v186, v186
    v_exp_f32 v187, v187
    v_exp_f32 v188, v188
    v_mfma_f32_32x32x16_bf16 v[144:159], v[12:15], v[208:211], v[144:159]
    ds_read_b128 v[40:43], v217 offset:54144
    v_exp_f32 v189, v189
    v_exp_f32 v190, v190
    v_exp_f32 v191, v191
    s_waitcnt vmcnt(0)
    s_barrier
    s_add_u32 s85, s24, 3
    s_and_b32 s85, s85, 7
    s_add_u32 s85, s85, s69
    s_mul_i32 s85, s85, 19456
    s_add_u32 s85, s85, 17825792
    s_add_u32 s85, s85, s83
    s_setprio 3
    v_exp_f32 v128, v128
    v_exp_f32 v129, v129
    v_smfmac_f32_32x32x32_bf16 v[192:207], v[56:59], v[184:191], v214
    ds_read_b32 v24, v216 offset:18432
    v_exp_f32 v130, v130
    v_exp_f32 v131, v131
    v_exp_f32 v132, v132
    s_waitcnt lgkmcnt(4)
    v_mfma_f32_32x32x4bf16_1k v[160:191], v[26:27], v[212:213], 0
    ds_read_b128 v[44:47], v217 offset:54784
    s_add_u32 m0, s83, 57088
    s_add_u32 s86, s85, 0
    buffer_load_dwordx4 v218, s[4:7], s86 offen sc1  lds
    v_exp_f32 v133, v133
    v_exp_f32 v134, v134
    v_exp_f32 v135, v135
    v_exp_f32 v136, v136
    v_exp_f32 v137, v137
    v_exp_f32 v138, v138
    v_exp_f32 v139, v139
    v_exp_f32 v140, v140
    v_smfmac_f32_32x32x32_bf16 v[192:207], v[28:31], v[128:135], v214
    ds_read_b128 v[48:51], v217 offset:55424
    v_exp_f32 v141, v141
    v_exp_f32 v142, v142
    v_exp_f32 v143, v143
    v_exp_f32 v144, v144
    v_exp_f32 v145, v145
    v_smfmac_f32_32x32x32_bf16 v[192:207], v[32:35], v[136:143], v214
    ds_read_b128 v[8:11], v215 offset:0
    v_exp_f32 v146, v146
    v_exp_f32 v147, v147
    v_exp_f32 v148, v148
    v_exp_f32 v149, v149
    v_mfma_f32_32x32x16_bf16 v[160:175], v[16:19], v[208:211], v[160:175]
    ds_read_b128 v[52:55], v217 offset:56064
    s_add_u32 m0, s83, 65280
    s_add_u32 s86, s85, 8192
    buffer_load_dwordx4 v218, s[4:7], s86 offen sc1  lds
    v_exp_f32 v150, v150
    v_exp_f32 v151, v151
    v_exp_f32 v152, v152
    v_exp_f32 v153, v153
    s_waitcnt lgkmcnt(5)
    v_smfmac_f32_32x32x32_bf16 v[192:207], v[36:39], v[144:151], v214
    ds_read_b128 v[12:15], v215 offset:1024
    v_exp_f32 v154, v154
    v_exp_f32 v155, v155
    v_exp_f32 v156, v156
    v_mfma_f32_32x32x16_bf16 v[176:191], v[20:23], v[208:211], v[176:191]
    ds_read_b128 v[56:59], v217 offset:56704
    v_exp_f32 v157, v157
    v_exp_f32 v158, v158
    v_exp_f32 v159, v159
    s_setprio 2
    v_exp_f32 v160, v160
    v_exp_f32 v161, v161
    v_smfmac_f32_32x32x32_bf16 v[192:207], v[40:43], v[152:159], v214
    ds_read_b32 v26, v216 offset:18688
    v_exp_f32 v162, v162
    v_exp_f32 v163, v163
    v_exp_f32 v164, v164
    s_waitcnt lgkmcnt(4)
    v_mfma_f32_32x32x4bf16_1k v[128:159], v[24:25], v[212:213], 0
    ds_read_b128 v[28:31], v217 offset:8192
    s_cmp_ge_u32 s26, 3
    s_cbranch_scc1 L_49
    s_add_u32 m0, s83, 73472
    s_add_u32 s86, s85, 16384
    buffer_load_dwordx4 v218, s[4:7], s86 offen sc1  lds
L_49:
    v_exp_f32 v165, v165
    v_exp_f32 v166, v166
    v_exp_f32 v167, v167
    v_exp_f32 v168, v168
    v_exp_f32 v169, v169
    v_exp_f32 v170, v170
    v_exp_f32 v171, v171
    v_exp_f32 v172, v172
    v_smfmac_f32_32x32x32_bf16 v[192:207], v[44:47], v[160:167], v214
    ds_read_b128 v[32:35], v217 offset:8832
    v_exp_f32 v173, v173
    v_exp_f32 v174, v174
    v_exp_f32 v175, v175
    v_exp_f32 v176, v176
    v_exp_f32 v177, v177
    v_smfmac_f32_32x32x32_bf16 v[192:207], v[48:51], v[168:175], v214
    ds_read_b128 v[16:19], v215 offset:2048
    v_exp_f32 v178, v178
    v_exp_f32 v179, v179
    v_exp_f32 v180, v180
    v_exp_f32 v181, v181
    v_mfma_f32_32x32x16_bf16 v[128:143], v[8:11], v[208:211], v[128:143]
    ds_read_b128 v[36:39], v217 offset:9472
    s_add_u32 m0, s83, 0
    s_add_u32 s86, s84, 0
    buffer_load_dwordx4 v218, s[4:7], s86 offen sc1  lds
    v_exp_f32 v182, v182
    v_exp_f32 v183, v183
    v_exp_f32 v184, v184
    v_exp_f32 v185, v185
    s_waitcnt lgkmcnt(5)
    v_smfmac_f32_32x32x32_bf16 v[192:207], v[52:55], v[176:183], v214
    ds_read_b128 v[20:23], v215 offset:3072
    v_exp_f32 v186, v186
    v_exp_f32 v187, v187
    v_exp_f32 v188, v188
    v_mfma_f32_32x32x16_bf16 v[144:159], v[12:15], v[208:211], v[144:159]
    ds_read_b128 v[40:43], v217 offset:10112
    v_exp_f32 v189, v189
    v_exp_f32 v190, v190
    v_exp_f32 v191, v191
    s_setprio 1
    v_exp_f32 v128, v128
    v_exp_f32 v129, v129
    v_smfmac_f32_32x32x32_bf16 v[192:207], v[56:59], v[184:191], v214
    ds_read_b32 v24, v216 offset:18944
    v_exp_f32 v130, v130
    v_exp_f32 v131, v131
    v_exp_f32 v132, v132
    s_waitcnt lgkmcnt(4)
    v_mfma_f32_32x32x4bf16_1k v[160:191], v[26:27], v[212:213], 0
    ds_read_b128 v[44:47], v217 offset:10752
    v_exp_f32 v133, v133
    v_exp_f32 v134, v134
    v_exp_f32 v135, v135
    v_exp_f32 v136, v136
    v_exp_f32 v137, v137
    v_exp_f32 v138, v138
    v_exp_f32 v139, v139
    v_exp_f32 v140, v140
    v_smfmac_f32_32x32x32_bf16 v[192:207], v[28:31], v[128:135], v214
    ds_read_b128 v[48:51], v217 offset:11392
    v_exp_f32 v141, v141
    v_exp_f32 v142, v142
    v_exp_f32 v143, v143
    v_exp_f32 v144, v144
    v_exp_f32 v145, v145
    v_smfmac_f32_32x32x32_bf16 v[192:207], v[32:35], v[136:143], v214
    ds_read_b128 v[8:11], v215 offset:4096
    v_exp_f32 v146, v146
    v_exp_f32 v147, v147
    v_exp_f32 v148, v148
    v_exp_f32 v149, v149
    v_mfma_f32_32x32x16_bf16 v[160:175], v[16:19], v[208:211], v[160:175]
    ds_read_b128 v[52:55], v217 offset:12032
    v_exp_f32 v150, v150
    v_exp_f32 v151, v151
    v_exp_f32 v152, v152
    v_exp_f32 v153, v153
    s_waitcnt lgkmcnt(5)
    v_smfmac_f32_32x32x32_bf16 v[192:207], v[36:39], v[144:151], v214
    ds_read_b128 v[12:15], v215 offset:5120
    v_exp_f32 v154, v154
    v_exp_f32 v155, v155
    v_exp_f32 v156, v156
    v_mfma_f32_32x32x16_bf16 v[176:191], v[20:23], v[208:211], v[176:191]
    ds_read_b128 v[56:59], v217 offset:12672
    v_exp_f32 v157, v157
    v_exp_f32 v158, v158
    v_exp_f32 v159, v159
    s_setprio 0
    v_exp_f32 v160, v160
    v_exp_f32 v161, v161
    v_smfmac_f32_32x32x32_bf16 v[192:207], v[40:43], v[152:159], v214
    ds_read_b32 v26, v216 offset:19200
    v_exp_f32 v162, v162
    v_exp_f32 v163, v163
    v_exp_f32 v164, v164
    s_waitcnt lgkmcnt(4)
    v_mfma_f32_32x32x4bf16_1k v[128:159], v[24:25], v[212:213], 0
    ds_read_b128 v[28:31], v217 offset:13312
    v_exp_f32 v165, v165
    v_exp_f32 v166, v166
    v_exp_f32 v167, v167
    v_exp_f32 v168, v168
    v_exp_f32 v169, v169
    v_exp_f32 v170, v170
    v_exp_f32 v171, v171
    v_exp_f32 v172, v172
    v_smfmac_f32_32x32x32_bf16 v[192:207], v[44:47], v[160:167], v214
    ds_read_b128 v[32:35], v217 offset:13952
    v_exp_f32 v173, v173
    v_exp_f32 v174, v174
    v_exp_f32 v175, v175
    v_exp_f32 v176, v176
    v_exp_f32 v177, v177
    v_smfmac_f32_32x32x32_bf16 v[192:207], v[48:51], v[168:175], v214
    ds_read_b128 v[16:19], v215 offset:6144
    v_exp_f32 v178, v178
    v_exp_f32 v179, v179
    v_exp_f32 v180, v180
    v_exp_f32 v181, v181
    v_mfma_f32_32x32x16_bf16 v[128:143], v[8:11], v[208:211], v[128:143]
    ds_read_b128 v[36:39], v217 offset:14592
    v_exp_f32 v182, v182
    v_exp_f32 v183, v183
    v_exp_f32 v184, v184
    v_exp_f32 v185, v185
    s_waitcnt lgkmcnt(5)
    v_smfmac_f32_32x32x32_bf16 v[192:207], v[52:55], v[176:183], v214
    ds_read_b128 v[20:23], v215 offset:7168
    v_exp_f32 v186, v186
    v_exp_f32 v187, v187
    v_exp_f32 v188, v188
    v_mfma_f32_32x32x16_bf16 v[144:159], v[12:15], v[208:211], v[144:159]
    ds_read_b128 v[40:43], v217 offset:15232
    v_exp_f32 v189, v189
    v_exp_f32 v190, v190
    v_exp_f32 v191, v191
    s_waitcnt vmcnt(0)
    s_barrier
    s_add_u32 s85, s24, 4
    s_and_b32 s85, s85, 7
    s_add_u32 s85, s85, s69
    s_mul_i32 s85, s85, 19456
    s_add_u32 s85, s85, 17825792
    s_add_u32 s85, s85, s83
    s_setprio 3
    v_exp_f32 v128, v128
    v_exp_f32 v129, v129
    v_smfmac_f32_32x32x32_bf16 v[192:207], v[56:59], v[184:191], v214
    ds_read_b32 v24, v216 offset:37888
    v_exp_f32 v130, v130
    v_exp_f32 v131, v131
    v_exp_f32 v132, v132
    s_waitcnt lgkmcnt(4)
    v_mfma_f32_32x32x4bf16_1k v[160:191], v[26:27], v[212:213], 0
    ds_read_b128 v[44:47], v217 offset:15872
    s_add_u32 m0, s83, 76544
    s_add_u32 s86, s85, 0
    buffer_load_dwordx4 v218, s[4:7], s86 offen sc1  lds
    v_exp_f32 v133, v133
    v_exp_f32 v134, v134
    v_exp_f32 v135, v135
    v_exp_f32 v136, v136
    v_exp_f32 v137, v137
    v_exp_f32 v138, v138
    v_exp_f32 v139, v139
    v_exp_f32 v140, v140
    v_smfmac_f32_32x32x32_bf16 v[192:207], v[28:31], v[128:135], v214
    ds_read_b128 v[48:51], v217 offset:16512
    v_exp_f32 v141, v141
    v_exp_f32 v142, v142
    v_exp_f32 v143, v143
    v_exp_f32 v144, v144
    v_exp_f32 v145, v145
    v_smfmac_f32_32x32x32_bf16 v[192:207], v[32:35], v[136:143], v214
    ds_read_b128 v[8:11], v215 offset:19456
    v_exp_f32 v146, v146
    v_exp_f32 v147, v147
    v_exp_f32 v148, v148
    v_exp_f32 v149, v149
    v_mfma_f32_32x32x16_bf16 v[160:175], v[16:19], v[208:211], v[160:175]
    ds_read_b128 v[52:55], v217 offset:17152
    s_add_u32 m0, s83, 84736
    s_add_u32 s86, s85, 8192
    buffer_load_dwordx4 v218, s[4:7], s86 offen sc1  lds
    v_exp_f32 v150, v150
    v_exp_f32 v151, v151
    v_exp_f32 v152, v152
    v_exp_f32 v153, v153
    s_waitcnt lgkmcnt(5)
    v_smfmac_f32_32x32x32_bf16 v[192:207], v[36:39], v[144:151], v214
    ds_read_b128 v[12:15], v215 offset:20480
    v_exp_f32 v154, v154
    v_exp_f32 v155, v155
    v_exp_f32 v156, v156
    v_mfma_f32_32x32x16_bf16 v[176:191], v[20:23], v[208:211], v[176:191]
    ds_read_b128 v[56:59], v217 offset:17792
    v_exp_f32 v157, v157
    v_exp_f32 v158, v158
    v_exp_f32 v159, v159
    s_setprio 2
    v_exp_f32 v160, v160
    v_exp_f32 v161, v161
    v_smfmac_f32_32x32x32_bf16 v[192:207], v[40:43], v[152:159], v214
    ds_read_b32 v26, v216 offset:38144
    v_exp_f32 v162, v162
    v_exp_f32 v163, v163
    v_exp_f32 v164, v164
    s_waitcnt lgkmcnt(4)
    v_mfma_f32_32x32x4bf16_1k v[128:159], v[24:25], v[212:213], 0
    ds_read_b128 v[28:31], v217 offset:27648
    s_cmp_ge_u32 s26, 3
    s_cbranch_scc1 L_53
    s_add_u32 m0, s83, 92928
    s_add_u32 s86, s85, 16384
    buffer_load_dwordx4 v218, s[4:7], s86 offen sc1  lds
L_53:
    v_exp_f32 v165, v165
    v_exp_f32 v166, v166
    v_exp_f32 v167, v167
    v_exp_f32 v168, v168
    v_exp_f32 v169, v169
    v_exp_f32 v170, v170
    v_exp_f32 v171, v171
    v_exp_f32 v172, v172
    v_smfmac_f32_32x32x32_bf16 v[192:207], v[44:47], v[160:167], v214
    ds_read_b128 v[32:35], v217 offset:28288
    v_exp_f32 v173, v173
    v_exp_f32 v174, v174
    v_exp_f32 v175, v175
    v_exp_f32 v176, v176
    v_exp_f32 v177, v177
    v_smfmac_f32_32x32x32_bf16 v[192:207], v[48:51], v[168:175], v214
    ds_read_b128 v[16:19], v215 offset:21504
    v_exp_f32 v178, v178
    v_exp_f32 v179, v179
    v_exp_f32 v180, v180
    v_exp_f32 v181, v181
    v_mfma_f32_32x32x16_bf16 v[128:143], v[8:11], v[208:211], v[128:143]
    ds_read_b128 v[36:39], v217 offset:28928
    s_add_u32 m0, s83, 8192
    s_add_u32 s86, s84, 8192
    buffer_load_dwordx4 v218, s[4:7], s86 offen sc1  lds
    v_exp_f32 v182, v182
    v_exp_f32 v183, v183
    v_exp_f32 v184, v184
    v_exp_f32 v185, v185
    s_waitcnt lgkmcnt(5)
    v_smfmac_f32_32x32x32_bf16 v[192:207], v[52:55], v[176:183], v214
    ds_read_b128 v[20:23], v215 offset:22528
    v_exp_f32 v186, v186
    v_exp_f32 v187, v187
    v_exp_f32 v188, v188
    v_mfma_f32_32x32x16_bf16 v[144:159], v[12:15], v[208:211], v[144:159]
    ds_read_b128 v[40:43], v217 offset:29568
    v_exp_f32 v189, v189
    v_exp_f32 v190, v190
    v_exp_f32 v191, v191
    s_setprio 1
    v_exp_f32 v128, v128
    v_exp_f32 v129, v129
    v_smfmac_f32_32x32x32_bf16 v[192:207], v[56:59], v[184:191], v214
    ds_read_b32 v24, v216 offset:38400
    v_exp_f32 v130, v130
    v_exp_f32 v131, v131
    v_exp_f32 v132, v132
    s_waitcnt lgkmcnt(4)
    v_mfma_f32_32x32x4bf16_1k v[160:191], v[26:27], v[212:213], 0
    ds_read_b128 v[44:47], v217 offset:30208
    s_cmp_ge_u32 s26, 4
    s_cbranch_scc1 L_55
    buffer_load_dwordx2 v[74:75], v72, s[4:7], s78 offen sc1
L_55:
    v_exp_f32 v133, v133
    v_exp_f32 v134, v134
    v_exp_f32 v135, v135
    v_exp_f32 v136, v136
    v_exp_f32 v137, v137
    v_exp_f32 v138, v138
    v_exp_f32 v139, v139
    v_exp_f32 v140, v140
    v_smfmac_f32_32x32x32_bf16 v[192:207], v[28:31], v[128:135], v214
    ds_read_b128 v[48:51], v217 offset:30848
    v_exp_f32 v141, v141
    v_exp_f32 v142, v142
    v_exp_f32 v143, v143
    v_exp_f32 v144, v144
    v_exp_f32 v145, v145
    v_smfmac_f32_32x32x32_bf16 v[192:207], v[32:35], v[136:143], v214
    ds_read_b128 v[8:11], v215 offset:23552
    v_exp_f32 v146, v146
    v_exp_f32 v147, v147
    v_exp_f32 v148, v148
    v_exp_f32 v149, v149
    v_mfma_f32_32x32x16_bf16 v[160:175], v[16:19], v[208:211], v[160:175]
    ds_read_b128 v[52:55], v217 offset:31488
    v_exp_f32 v150, v150
    v_exp_f32 v151, v151
    v_exp_f32 v152, v152
    v_exp_f32 v153, v153
    s_waitcnt lgkmcnt(5)
    v_smfmac_f32_32x32x32_bf16 v[192:207], v[36:39], v[144:151], v214
    ds_read_b128 v[12:15], v215 offset:24576
    v_exp_f32 v154, v154
    v_exp_f32 v155, v155
    v_exp_f32 v156, v156
    v_mfma_f32_32x32x16_bf16 v[176:191], v[20:23], v[208:211], v[176:191]
    ds_read_b128 v[56:59], v217 offset:32128
    v_exp_f32 v157, v157
    v_exp_f32 v158, v158
    v_exp_f32 v159, v159
    s_setprio 0
    v_exp_f32 v160, v160
    v_exp_f32 v161, v161
    v_smfmac_f32_32x32x32_bf16 v[192:207], v[40:43], v[152:159], v214
    ds_read_b32 v26, v216 offset:38656
    v_exp_f32 v162, v162
    v_exp_f32 v163, v163
    v_exp_f32 v164, v164
    s_waitcnt lgkmcnt(4)
    v_mfma_f32_32x32x4bf16_1k v[128:159], v[24:25], v[212:213], 0
    ds_read_b128 v[28:31], v217 offset:32768
    v_exp_f32 v165, v165
    v_exp_f32 v166, v166
    v_exp_f32 v167, v167
    v_exp_f32 v168, v168
    v_exp_f32 v169, v169
    v_exp_f32 v170, v170
    v_exp_f32 v171, v171
    v_exp_f32 v172, v172
    v_smfmac_f32_32x32x32_bf16 v[192:207], v[44:47], v[160:167], v214
    ds_read_b128 v[32:35], v217 offset:33408
    v_exp_f32 v173, v173
    v_exp_f32 v174, v174
    v_exp_f32 v175, v175
    v_exp_f32 v176, v176
    v_exp_f32 v177, v177
    v_smfmac_f32_32x32x32_bf16 v[192:207], v[48:51], v[168:175], v214
    ds_read_b128 v[16:19], v215 offset:25600
    v_exp_f32 v178, v178
    v_exp_f32 v179, v179
    v_exp_f32 v180, v180
    v_exp_f32 v181, v181
    v_mfma_f32_32x32x16_bf16 v[128:143], v[8:11], v[208:211], v[128:143]
    ds_read_b128 v[36:39], v217 offset:34048
    v_exp_f32 v182, v182
    v_exp_f32 v183, v183
    v_exp_f32 v184, v184
    v_exp_f32 v185, v185
    s_waitcnt lgkmcnt(5)
    v_smfmac_f32_32x32x32_bf16 v[192:207], v[52:55], v[176:183], v214
    ds_read_b128 v[20:23], v215 offset:26624
    v_exp_f32 v186, v186
    v_exp_f32 v187, v187
    v_exp_f32 v188, v188
    v_mfma_f32_32x32x16_bf16 v[144:159], v[12:15], v[208:211], v[144:159]
    ds_read_b128 v[40:43], v217 offset:34688
    v_exp_f32 v189, v189
    v_exp_f32 v190, v190
    v_exp_f32 v191, v191
    s_waitcnt vmcnt(0)
    s_barrier
    s_cmp_ge_u32 s26, 4
    s_cbranch_scc1 L_56
    v_cmp_ne_u64 vcc, s[28:29], v[74:75]
    s_nop 0
    s_cmp_eq_u64 vcc, 0
    s_cbranch_scc1 L_56
    s_mov_b32 s96, 400000
Lpoll_57:
    buffer_load_dwordx2 v[74:75], v72, s[4:7], s78 offen offset:0 sc1
    s_waitcnt vmcnt(0)
    v_cmp_ne_u64 vcc, s[28:29], v[74:75]
    s_nop 0
    s_cmp_eq_u64 vcc, 0
    s_cbranch_scc1 Lpolld_58
    s_mov_b64 exec, vcc
    s_sleep 1
    s_sub_u32 s96, s96, 1
    s_cmp_lg_u32 s96, 0
    s_cbranch_scc1 Lpoll_57
    v_mov_b32 v74, 10
    v_mov_b32 v75, 0
    global_store_dword v75, v74, s[52:53]
    s_waitcnt vmcnt(0)
Lpolld_58:
    s_mov_b64 exec, -1
L_56:
    s_add_u32 s85, s24, 5
    s_and_b32 s85, s85, 7
    s_add_u32 s85, s85, s69
    s_mul_i32 s85, s85, 19456
    s_add_u32 s85, s85, 17825792
    s_add_u32 s85, s85, s83
    s_setprio 3
    v_exp_f32 v128, v128
    v_exp_f32 v129, v129
    v_smfmac_f32_32x32x32_bf16 v[192:207], v[56:59], v[184:191], v214
    ds_read_b32 v24, v216 offset:57344
    v_exp_f32 v130, v130
    v_exp_f32 v131, v131
    v_exp_f32 v132, v132
    s_waitcnt lgkmcnt(4)
    v_mfma_f32_32x32x4bf16_1k v[160:191], v[26:27], v[212:213], 0
    ds_read_b128 v[44:47], v217 offset:35328
    s_add_u32 m0, s83, 37632
    s_add_u32 s86, s85, 0
    buffer_load_dwordx4 v218, s[4:7], s86 offen sc1  lds
    v_exp_f32 v133, v133
    v_exp_f32 v134, v134
    v_exp_f32 v135, v135
    v_exp_f32 v136, v136
    v_exp_f32 v137, v137
    v_exp_f32 v138, v138
    v_exp_f32 v139, v139
    v_exp_f32 v140, v140
    v_smfmac_f32_32x32x32_bf16 v[192:207], v[28:31], v[128:135], v214
    ds_read_b128 v[48:51], v217 offset:35968
    v_exp_f32 v141, v141
    v_exp_f32 v142, v142
    v_exp_f32 v143, v143
    v_exp_f32 v144, v144
    v_exp_f32 v145, v145
    v_smfmac_f32_32x32x32_bf16 v[192:207], v[32:35], v[136:143], v214
    ds_read_b128 v[8:11], v215 offset:38912
    v_exp_f32 v146, v146
    v_exp_f32 v147, v147
    v_exp_f32 v148, v148
    v_exp_f32 v149, v149
    v_mfma_f32_32x32x16_bf16 v[160:175], v[16:19], v[208:211], v[160:175]
    ds_read_b128 v[52:55], v217 offset:36608
    s_add_u32 m0, s83, 45824
    s_add_u32 s86, s85, 8192
    buffer_load_dwordx4 v218, s[4:7], s86 offen sc1  lds
    v_exp_f32 v150, v150
    v_exp_f32 v151, v151
    v_exp_f32 v152, v152
    v_exp_f32 v153, v153
    s_waitcnt lgkmcnt(5)
    v_smfmac_f32_32x32x32_bf16 v[192:207], v[36:39], v[144:151], v214
    ds_read_b128 v[12:15], v215 offset:39936
    v_exp_f32 v154, v154
    v_exp_f32 v155, v155
    v_exp_f32 v156, v156
    v_mfma_f32_32x32x16_bf16 v[176:191], v[20:23], v[208:211], v[176:191]
    ds_read_b128 v[56:59], v217 offset:37248
    v_exp_f32 v157, v157
    v_exp_f32 v158, v158
    v_exp_f32 v159, v159
    s_setprio 2
    v_exp_f32 v160, v160
    v_exp_f32 v161, v161
    v_smfmac_f32_32x32x32_bf16 v[192:207], v[40:43], v[152:159], v214
    ds_read_b32 v26, v216 offset:57600
    v_exp_f32 v162, v162
    v_exp_f32 v163, v163
    v_exp_f32 v164, v164
    s_waitcnt lgkmcnt(4)
    v_mfma_f32_32x32x4bf16_1k v[128:159], v[24:25], v[212:213], 0
    ds_read_b128 v[28:31], v217 offset:47104
    s_cmp_ge_u32 s26, 3
    s_cbranch_scc1 L_61
    s_add_u32 m0, s83, 54016
    s_add_u32 s86, s85, 16384
    buffer_load_dwordx4 v218, s[4:7], s86 offen sc1  lds
L_61:
    v_exp_f32 v165, v165
    v_exp_f32 v166, v166
    v_exp_f32 v167, v167
    v_exp_f32 v168, v168
    v_exp_f32 v169, v169
    v_exp_f32 v170, v170
    v_exp_f32 v171, v171
    v_exp_f32 v172, v172
    v_smfmac_f32_32x32x32_bf16 v[192:207], v[44:47], v[160:167], v214
    ds_read_b128 v[32:35], v217 offset:47744
    v_exp_f32 v173, v173
    v_exp_f32 v174, v174
    v_exp_f32 v175, v175
    v_exp_f32 v176, v176
    v_exp_f32 v177, v177
    v_smfmac_f32_32x32x32_bf16 v[192:207], v[48:51], v[168:175], v214
    ds_read_b128 v[16:19], v215 offset:40960
    v_exp_f32 v178, v178
    v_exp_f32 v179, v179
    v_exp_f32 v180, v180
    v_exp_f32 v181, v181
    v_mfma_f32_32x32x16_bf16 v[128:143], v[8:11], v[208:211], v[128:143]
    ds_read_b128 v[36:39], v217 offset:48384
    s_add_u32 m0, s83, 16384
    s_add_u32 s86, s84, 16384
    buffer_load_dwordx4 v218, s[4:7], s86 offen sc1  lds
    v_exp_f32 v182, v182
    v_exp_f32 v183, v183
    v_exp_f32 v184, v184
    v_exp_f32 v185, v185
    s_waitcnt lgkmcnt(5)
    v_smfmac_f32_32x32x32_bf16 v[192:207], v[52:55], v[176:183], v214
    ds_read_b128 v[20:23], v215 offset:41984
    v_exp_f32 v186, v186
    v_exp_f32 v187, v187
    v_exp_f32 v188, v188
    v_mfma_f32_32x32x16_bf16 v[144:159], v[12:15], v[208:211], v[144:159]
    ds_read_b128 v[40:43], v217 offset:49024
    v_exp_f32 v189, v189
    v_exp_f32 v190, v190
    v_exp_f32 v191, v191
    s_setprio 1
    v_exp_f32 v128, v128
    v_exp_f32 v129, v129
    v_smfmac_f32_32x32x32_bf16 v[192:207], v[56:59], v[184:191], v214
    ds_read_b32 v24, v216 offset:57856
    v_exp_f32 v130, v130
    v_exp_f32 v131, v131
    v_exp_f32 v132, v132
    s_waitcnt lgkmcnt(4)
    v_mfma_f32_32x32x4bf16_1k v[160:191], v[26:27], v[212:213], 0
    ds_read_b128 v[44:47], v217 offset:49664
    s_cmp_ge_u32 s26, 4
    s_cbranch_scc1 L_63
    s_add_u32 s60, s67, s68
    s_add_u32 s61, s67, 11534336
    buffer_load_dwordx2 v[76:77], v63, s[4:7], s60 offen offset:0 sc1
    buffer_load_dwordx2 v[86:87], v63, s[4:7], s61 offen offset:0 sc1
    buffer_load_dwordx2 v[78:79], v63, s[4:7], s60 offen offset:256 sc1
    buffer_load_dwordx2 v[88:89], v63, s[4:7], s61 offen offset:256 sc1
    buffer_load_dwordx2 v[80:81], v63, s[4:7], s60 offen offset:2048 sc1
    buffer_load_dwordx2 v[90:91], v63, s[4:7], s61 offen offset:2048 sc1
    buffer_load_dwordx2 v[82:83], v63, s[4:7], s60 offen offset:2304 sc1
    buffer_load_dwordx2 v[92:93], v63, s[4:7], s61 offen offset:2304 sc1
    buffer_load_dwordx2 v[84:85], v64, s[4:7], s60 offen offset:0 sc1
    buffer_load_dwordx2 v[94:95], v64, s[4:7], s61 offen offset:0 sc1
L_63:
    v_exp_f32 v133, v133
    v_exp_f32 v134, v134
    v_exp_f32 v135, v135
    v_exp_f32 v136, v136
    v_exp_f32 v137, v137
    v_exp_f32 v138, v138
    v_exp_f32 v139, v139
    v_exp_f32 v140, v140
    v_smfmac_f32_32x32x32_bf16 v[192:207], v[28:31], v[128:135], v214
    ds_read_b128 v[48:51], v217 offset:50304
    v_exp_f32 v141, v141
    v_exp_f32 v142, v142
    v_exp_f32 v143, v143
    v_exp_f32 v144, v144
    v_exp_f32 v145, v145
    v_smfmac_f32_32x32x32_bf16 v[192:207], v[32:35], v[136:143], v214
    ds_read_b128 v[8:11], v215 offset:43008
    v_exp_f32 v146, v146
    v_exp_f32 v147, v147
    v_exp_f32 v148, v148
    v_exp_f32 v149, v149
    v_mfma_f32_32x32x16_bf16 v[160:175], v[16:19], v[208:211], v[160:175]
    ds_read_b128 v[52:55], v217 offset:50944
    v_exp_f32 v150, v150
    v_exp_f32 v151, v151
    v_exp_f32 v152, v152
    v_exp_f32 v153, v153
    s_waitcnt lgkmcnt(5)
    v_smfmac_f32_32x32x32_bf16 v[192:207], v[36:39], v[144:151], v214
    ds_read_b128 v[12:15], v215 offset:44032
    v_exp_f32 v154, v154
    v_exp_f32 v155, v155
    v_exp_f32 v156, v156
    v_mfma_f32_32x32x16_bf16 v[176:191], v[20:23], v[208:211], v[176:191]
    ds_read_b128 v[56:59], v217 offset:51584
    v_exp_f32 v157, v157
    v_exp_f32 v158, v158
    v_exp_f32 v159, v159
    s_setprio 0
    v_exp_f32 v160, v160
    v_exp_f32 v161, v161
    v_smfmac_f32_32x32x32_bf16 v[192:207], v[40:43], v[152:159], v214
    ds_read_b32 v26, v216 offset:58112
    v_exp_f32 v162, v162
    v_exp_f32 v163, v163
    v_exp_f32 v164, v164
    s_waitcnt lgkmcnt(4)
    v_mfma_f32_32x32x4bf16_1k v[128:159], v[24:25], v[212:213], 0
    ds_read_b128 v[28:31], v217 offset:52224
    v_exp_f32 v165, v165
    v_exp_f32 v166, v166
    v_exp_f32 v167, v167
    v_exp_f32 v168, v168
    v_exp_f32 v169, v169
    v_exp_f32 v170, v170
    v_exp_f32 v171, v171
    v_exp_f32 v172, v172
    v_smfmac_f32_32x32x32_bf16 v[192:207], v[44:47], v[160:167], v214
    ds_read_b128 v[32:35], v217 offset:52864
    v_exp_f32 v173, v173
    v_exp_f32 v174, v174
    v_exp_f32 v175, v175
    v_exp_f32 v176, v176
    v_exp_f32 v177, v177
    v_smfmac_f32_32x32x32_bf16 v[192:207], v[48:51], v[168:175], v214
    ds_read_b128 v[16:19], v215 offset:45056
    v_exp_f32 v178, v178
    v_exp_f32 v179, v179
    v_exp_f32 v180, v180
    v_exp_f32 v181, v181
    v_mfma_f32_32x32x16_bf16 v[128:143], v[8:11], v[208:211], v[128:143]
    ds_read_b128 v[36:39], v217 offset:53504
    v_exp_f32 v182, v182
    v_exp_f32 v183, v183
    v_exp_f32 v184, v184
    v_exp_f32 v185, v185
    s_waitcnt lgkmcnt(5)
    v_smfmac_f32_32x32x32_bf16 v[192:207], v[52:55], v[176:183], v214
    ds_read_b128 v[20:23], v215 offset:46080
    v_exp_f32 v186, v186
    v_exp_f32 v187, v187
    v_exp_f32 v188, v188
    v_mfma_f32_32x32x16_bf16 v[144:159], v[12:15], v[208:211], v[144:159]
    ds_read_b128 v[40:43], v217 offset:54144
    v_exp_f32 v189, v189
    v_exp_f32 v190, v190
    v_exp_f32 v191, v191
    s_waitcnt vmcnt(0)
    s_barrier
    s_add_u32 s85, s24, 6
    s_and_b32 s85, s85, 7
    s_add_u32 s85, s85, s69
    s_mul_i32 s85, s85, 19456
    s_add_u32 s85, s85, 17825792
    s_add_u32 s85, s85, s83
    s_setprio 3
    v_exp_f32 v128, v128
    v_exp_f32 v129, v129
    v_smfmac_f32_32x32x32_bf16 v[192:207], v[56:59], v[184:191], v214
    ds_read_b32 v24, v216 offset:18432
    v_exp_f32 v130, v130
    v_exp_f32 v131, v131
    v_exp_f32 v132, v132
    s_waitcnt lgkmcnt(4)
    v_mfma_f32_32x32x4bf16_1k v[160:191], v[26:27], v[212:213], 0
    ds_read_b128 v[44:47], v217 offset:54784
    s_add_u32 m0, s83, 57088
    s_add_u32 s86, s85, 0
    buffer_load_dwordx4 v218, s[4:7], s86 offen sc1  lds
    v_exp_f32 v133, v133
    v_exp_f32 v134, v134
    v_exp_f32 v135, v135
    v_exp_f32 v136, v136
    v_exp_f32 v137, v137
    v_exp_f32 v138, v138
    v_exp_f32 v139, v139
    v_exp_f32 v140, v140
    v_smfmac_f32_32x32x32_bf16 v[192:207], v[28:31], v[128:135], v214
    ds_read_b128 v[48:51], v217 offset:55424
    v_exp_f32 v141, v141
    v_exp_f32 v142, v142
    v_exp_f32 v143, v143
    v_exp_f32 v144, v144
    v_exp_f32 v145, v145
    v_smfmac_f32_32x32x32_bf16 v[192:207], v[32:35], v[136:143], v214
    ds_read_b128 v[8:11], v215 offset:0
    v_exp_f32 v146, v146
    v_exp_f32 v147, v147
    v_exp_f32 v148, v148
    v_exp_f32 v149, v149
    v_mfma_f32_32x32x16_bf16 v[160:175], v[16:19], v[208:211], v[160:175]
    ds_read_b128 v[52:55], v217 offset:56064
    s_add_u32 m0, s83, 65280
    s_add_u32 s86, s85, 8192
    buffer_load_dwordx4 v218, s[4:7], s86 offen sc1  lds
    v_exp_f32 v150, v150
    v_exp_f32 v151, v151
    v_exp_f32 v152, v152
    v_exp_f32 v153, v153
    s_waitcnt lgkmcnt(5)
    v_smfmac_f32_32x32x32_bf16 v[192:207], v[36:39], v[144:151], v214
    ds_read_b128 v[12:15], v215 offset:1024
    v_exp_f32 v154, v154
    v_exp_f32 v155, v155
    v_exp_f32 v156, v156
    v_mfma_f32_32x32x16_bf16 v[176:191], v[20:23], v[208:211], v[176:191]
    ds_read_b128 v[56:59], v217 offset:56704
    v_exp_f32 v157, v157
    v_exp_f32 v158, v158
    v_exp_f32 v159, v159
    s_setprio 2
    v_exp_f32 v160, v160
    v_exp_f32 v161, v161
    v_smfmac_f32_32x32x32_bf16 v[192:207], v[40:43], v[152:159], v214
    ds_read_b32 v26, v216 offset:18688
    v_exp_f32 v162, v162
    v_exp_f32 v163, v163
    v_exp_f32 v164, v164
    s_waitcnt lgkmcnt(4)
    v_mfma_f32_32x32x4bf16_1k v[128:159], v[24:25], v[212:213], 0
    ds_read_b128 v[28:31], v217 offset:8192
    s_cmp_ge_u32 s26, 3
    s_cbranch_scc1 L_66
    s_add_u32 m0, s83, 73472
    s_add_u32 s86, s85, 16384
    buffer_load_dwordx4 v218, s[4:7], s86 offen sc1  lds
L_66:
    v_exp_f32 v165, v165
    v_exp_f32 v166, v166
    v_exp_f32 v167, v167
    v_exp_f32 v168, v168
    v_exp_f32 v169, v169
    v_exp_f32 v170, v170
    v_exp_f32 v171, v171
    v_exp_f32 v172, v172
    v_smfmac_f32_32x32x32_bf16 v[192:207], v[44:47], v[160:167], v214
    ds_read_b128 v[32:35], v217 offset:8832
    v_exp_f32 v173, v173
    v_exp_f32 v174, v174
    v_exp_f32 v175, v175
    v_exp_f32 v176, v176
    v_exp_f32 v177, v177
    v_smfmac_f32_32x32x32_bf16 v[192:207], v[48:51], v[168:175], v214
    ds_read_b128 v[16:19], v215 offset:2048
    v_exp_f32 v178, v178
    v_exp_f32 v179, v179
    v_exp_f32 v180, v180
    v_exp_f32 v181, v181
    v_mfma_f32_32x32x16_bf16 v[128:143], v[8:11], v[208:211], v[128:143]
    ds_read_b128 v[36:39], v217 offset:9472
    s_add_u32 m0, s83, 24576
    s_add_u32 s86, s84, 24576
    buffer_load_dwordx4 v218, s[4:7], s86 offen sc1  lds
    v_exp_f32 v182, v182
    v_exp_f32 v183, v183
    v_exp_f32 v184, v184
    v_exp_f32 v185, v185
    s_waitcnt lgkmcnt(5)
    v_smfmac_f32_32x32x32_bf16 v[192:207], v[52:55], v[176:183], v214
    ds_read_b128 v[20:23], v215 offset:3072
    v_exp_f32 v186, v186
    v_exp_f32 v187, v187
    v_exp_f32 v188, v188
    v_mfma_f32_32x32x16_bf16 v[144:159], v[12:15], v[208:211], v[144:159]
    ds_read_b128 v[40:43], v217 offset:10112
    v_exp_f32 v189, v189
    v_exp_f32 v190, v190
    v_exp_f32 v191, v191
    s_setprio 1
    v_exp_f32 v128, v128
    v_exp_f32 v129, v129
    v_smfmac_f32_32x32x32_bf16 v[192:207], v[56:59], v[184:191], v214
    ds_read_b32 v24, v216 offset:18944
    v_exp_f32 v130, v130
    v_exp_f32 v131, v131
    v_exp_f32 v132, v132
    s_waitcnt lgkmcnt(4)
    v_mfma_f32_32x32x4bf16_1k v[160:191], v[26:27], v[212:213], 0
    ds_read_b128 v[44:47], v217 offset:10752
    v_exp_f32 v133, v133
    v_exp_f32 v134, v134
    v_exp_f32 v135, v135
    v_exp_f32 v136, v136
    v_exp_f32 v137, v137
    v_exp_f32 v138, v138
    v_exp_f32 v139, v139
    v_exp_f32 v140, v140
    v_smfmac_f32_32x32x32_bf16 v[192:207], v[28:31], v[128:135], v214
    ds_read_b128 v[48:51], v217 offset:11392
    v_exp_f32 v141, v141
    v_exp_f32 v142, v142
    v_exp_f32 v143, v143
    v_exp_f32 v144, v144
    v_exp_f32 v145, v145
    v_smfmac_f32_32x32x32_bf16 v[192:207], v[32:35], v[136:143], v214
    ds_read_b128 v[8:11], v215 offset:4096
    v_exp_f32 v146, v146
    v_exp_f32 v147, v147
    v_exp_f32 v148, v148
    v_exp_f32 v149, v149
    v_mfma_f32_32x32x16_bf16 v[160:175], v[16:19], v[208:211], v[160:175]
    ds_read_b128 v[52:55], v217 offset:12032
    v_exp_f32 v150, v150
    v_exp_f32 v151, v151
    v_exp_f32 v152, v152
    v_exp_f32 v153, v153
    s_waitcnt lgkmcnt(5)
    v_smfmac_f32_32x32x32_bf16 v[192:207], v[36:39], v[144:151], v214
    ds_read_b128 v[12:15], v215 offset:5120
    v_exp_f32 v154, v154
    v_exp_f32 v155, v155
    v_exp_f32 v156, v156
    v_mfma_f32_32x32x16_bf16 v[176:191], v[20:23], v[208:211], v[176:191]
    ds_read_b128 v[56:59], v217 offset:12672
    v_exp_f32 v157, v157
    v_exp_f32 v158, v158
    v_exp_f32 v159, v159
    s_setprio 0
    v_exp_f32 v160, v160
    v_exp_f32 v161, v161
    v_smfmac_f32_32x32x32_bf16 v[192:207], v[40:43], v[152:159], v214
    ds_read_b32 v26, v216 offset:19200
    v_exp_f32 v162, v162
    v_exp_f32 v163, v163
    v_exp_f32 v164, v164
    s_waitcnt lgkmcnt(4)
    v_mfma_f32_32x32x4bf16_1k v[128:159], v[24:25], v[212:213], 0
    ds_read_b128 v[28:31], v217 offset:13312
    v_exp_f32 v165, v165
    v_exp_f32 v166, v166
    v_exp_f32 v167, v167
    v_exp_f32 v168, v168
    v_exp_f32 v169, v169
    v_exp_f32 v170, v170
    v_exp_f32 v171, v171
    v_exp_f32 v172, v172
    v_smfmac_f32_32x32x32_bf16 v[192:207], v[44:47], v[160:167], v214
    ds_read_b128 v[32:35], v217 offset:13952
    v_exp_f32 v173, v173
    v_exp_f32 v174, v174
    v_exp_f32 v175, v175
    v_exp_f32 v176, v176
    v_exp_f32 v177, v177
    v_smfmac_f32_32x32x32_bf16 v[192:207], v[48:51], v[168:175], v214
    ds_read_b128 v[16:19], v215 offset:6144
    v_exp_f32 v178, v178
    v_exp_f32 v179, v179
    v_exp_f32 v180, v180
    v_exp_f32 v181, v181
    v_mfma_f32_32x32x16_bf16 v[128:143], v[8:11], v[208:211], v[128:143]
    ds_read_b128 v[36:39], v217 offset:14592
    v_exp_f32 v182, v182
    v_exp_f32 v183, v183
    v_exp_f32 v184, v184
    v_exp_f32 v185, v185
    s_waitcnt lgkmcnt(5)
    v_smfmac_f32_32x32x32_bf16 v[192:207], v[52:55], v[176:183], v214
    ds_read_b128 v[20:23], v215 offset:7168
    v_exp_f32 v186, v186
    v_exp_f32 v187, v187
    v_exp_f32 v188, v188
    v_mfma_f32_32x32x16_bf16 v[144:159], v[12:15], v[208:211], v[144:159]
    ds_read_b128 v[40:43], v217 offset:15232
    v_exp_f32 v189, v189
    v_exp_f32 v190, v190
    v_exp_f32 v191, v191
    s_waitcnt vmcnt(0)
    s_barrier
    s_add_u32 s85, s24, 7
    s_and_b32 s85, s85, 7
    s_add_u32 s85, s85, s69
    s_mul_i32 s85, s85, 19456
    s_add_u32 s85, s85, 17825792
    s_add_u32 s85, s85, s83
    s_setprio 3
    v_exp_f32 v128, v128
    v_exp_f32 v129, v129
    v_smfmac_f32_32x32x32_bf16 v[192:207], v[56:59], v[184:191], v214
    ds_read_b32 v24, v216 offset:37888
    v_exp_f32 v130, v130
    v_exp_f32 v131, v131
    v_exp_f32 v132, v132
    s_waitcnt lgkmcnt(4)
    v_mfma_f32_32x32x4bf16_1k v[160:191], v[26:27], v[212:213], 0
    ds_read_b128 v[44:47], v217 offset:15872
    s_add_u32 m0, s83, 76544
    s_add_u32 s86, s85, 0
    buffer_load_dwordx4 v218, s[4:7], s86 offen sc1  lds
    v_exp_f32 v133, v133
    v_exp_f32 v134, v134
    v_exp_f32 v135, v135
    v_exp_f32 v136, v136
    v_exp_f32 v137, v137
    v_exp_f32 v138, v138
    v_exp_f32 v139, v139
    v_exp_f32 v140, v140
    v_smfmac_f32_32x32x32_bf16 v[192:207], v[28:31], v[128:135], v214
    ds_read_b128 v[48:51], v217 offset:16512
    v_exp_f32 v141, v141
    v_exp_f32 v142, v142
    v_exp_f32 v143, v143
    v_exp_f32 v144, v144
    v_exp_f32 v145, v145
    v_smfmac_f32_32x32x32_bf16 v[192:207], v[32:35], v[136:143], v214
    ds_read_b128 v[8:11], v215 offset:19456
    v_exp_f32 v146, v146
    v_exp_f32 v147, v147
    v_exp_f32 v148, v148
    v_exp_f32 v149, v149
    v_mfma_f32_32x32x16_bf16 v[160:175], v[16:19], v[208:211], v[160:175]
    ds_read_b128 v[52:55], v217 offset:17152
    s_add_u32 m0, s83, 84736
    s_add_u32 s86, s85, 8192
    buffer_load_dwordx4 v218, s[4:7], s86 offen sc1  lds
    v_exp_f32 v150, v150
    v_exp_f32 v151, v151
    v_exp_f32 v152, v152
    v_exp_f32 v153, v153
    s_waitcnt lgkmcnt(5)
    v_smfmac_f32_32x32x32_bf16 v[192:207], v[36:39], v[144:151], v214
    ds_read_b128 v[12:15], v215 offset:20480
    v_exp_f32 v154, v154
    v_exp_f32 v155, v155
    v_exp_f32 v156, v156
    v_mfma_f32_32x32x16_bf16 v[176:191], v[20:23], v[208:211], v[176:191]
    ds_read_b128 v[56:59], v217 offset:17792
    v_exp_f32 v157, v157
    v_exp_f32 v158, v158
    v_exp_f32 v159, v159
    s_setprio 2
    v_exp_f32 v160, v160
    v_exp_f32 v161, v161
    v_smfmac_f32_32x32x32_bf16 v[192:207], v[40:43], v[152:159], v214
    ds_read_b32 v26, v216 offset:38144
    v_exp_f32 v162, v162
    v_exp_f32 v163, v163
    v_exp_f32 v164, v164
    s_waitcnt lgkmcnt(4)
    v_mfma_f32_32x32x4bf16_1k v[128:159], v[24:25], v[212:213], 0
    ds_read_b128 v[28:31], v217 offset:27648
    s_cmp_ge_u32 s26, 3
    s_cbranch_scc1 L_70
    s_add_u32 m0, s83, 92928
    s_add_u32 s86, s85, 16384
    buffer_load_dwordx4 v218, s[4:7], s86 offen sc1  lds
L_70:
    v_exp_f32 v165, v165
    v_exp_f32 v166, v166
    v_exp_f32 v167, v167
    v_exp_f32 v168, v168
    v_exp_f32 v169, v169
    v_exp_f32 v170, v170
    v_exp_f32 v171, v171
    v_exp_f32 v172, v172
    v_smfmac_f32_32x32x32_bf16 v[192:207], v[44:47], v[160:167], v214
    ds_read_b128 v[32:35], v217 offset:28288
    v_exp_f32 v173, v173
    v_exp_f32 v174, v174
    v_exp_f32 v175, v175
    v_exp_f32 v176, v176
    v_exp_f32 v177, v177
    v_smfmac_f32_32x32x32_bf16 v[192:207], v[48:51], v[168:175], v214
    ds_read_b128 v[16:19], v215 offset:21504
    v_exp_f32 v178, v178
    v_exp_f32 v179, v179
    v_exp_f32 v180, v180
    v_exp_f32 v181, v181
    v_mfma_f32_32x32x16_bf16 v[128:143], v[8:11], v[208:211], v[128:143]
    ds_read_b128 v[36:39], v217 offset:28928
    s_cmp_ge_u32 s26, 4
    s_cbranch_scc1 L_71
    s_add_u32 m0, s83, 32768
    s_add_u32 s86, s84, 32768
    buffer_load_dwordx4 v218, s[4:7], s86 offen sc1  lds
L_71:
    v_exp_f32 v182, v182
    v_exp_f32 v183, v183
    v_exp_f32 v184, v184
    v_exp_f32 v185, v185
    s_waitcnt lgkmcnt(5)
    v_smfmac_f32_32x32x32_bf16 v[192:207], v[52:55], v[176:183], v214
    ds_read_b128 v[20:23], v215 offset:22528
    v_exp_f32 v186, v186
    v_exp_f32 v187, v187
    v_exp_f32 v188, v188
    v_mfma_f32_32x32x16_bf16 v[144:159], v[12:15], v[208:211], v[144:159]
    ds_read_b128 v[40:43], v217 offset:29568
    v_exp_f32 v189, v189
    v_exp_f32 v190, v190
    v_exp_f32 v191, v191
    s_setprio 1
    v_exp_f32 v128, v128
    v_exp_f32 v129, v129
    v_smfmac_f32_32x32x32_bf16 v[192:207], v[56:59], v[184:191], v214
    ds_read_b32 v24, v216 offset:38400
    v_exp_f32 v130, v130
    v_exp_f32 v131, v131
    v_exp_f32 v132, v132
    s_waitcnt lgkmcnt(4)
    v_mfma_f32_32x32x4bf16_1k v[160:191], v[26:27], v[212:213], 0
    ds_read_b128 v[44:47], v217 offset:30208
    v_exp_f32 v133, v133
    v_exp_f32 v134, v134
    v_exp_f32 v135, v135
    v_exp_f32 v136, v136
    v_exp_f32 v137, v137
    v_exp_f32 v138, v138
    v_exp_f32 v139, v139
    v_exp_f32 v140, v140
    v_smfmac_f32_32x32x32_bf16 v[192:207], v[28:31], v[128:135], v214
    ds_read_b128 v[48:51], v217 offset:30848
    v_exp_f32 v141, v141
    v_exp_f32 v142, v142
    v_exp_f32 v143, v143
    v_exp_f32 v144, v144
    v_exp_f32 v145, v145
    v_smfmac_f32_32x32x32_bf16 v[192:207], v[32:35], v[136:143], v214
    ds_read_b128 v[8:11], v215 offset:23552
    v_exp_f32 v146, v146
    v_exp_f32 v147, v147
    v_exp_f32 v148, v148
    v_exp_f32 v149, v149
    v_mfma_f32_32x32x16_bf16 v[160:175], v[16:19], v[208:211], v[160:175]
    ds_read_b128 v[52:55], v217 offset:31488
    v_exp_f32 v150, v150
    v_exp_f32 v151, v151
    v_exp_f32 v152, v152
    v_exp_f32 v153, v153
    s_waitcnt lgkmcnt(5)
    v_smfmac_f32_32x32x32_bf16 v[192:207], v[36:39], v[144:151], v214
    ds_read_b128 v[12:15], v215 offset:24576
    v_exp_f32 v154, v154
    v_exp_f32 v155, v155
    v_exp_f32 v156, v156
    v_mfma_f32_32x32x16_bf16 v[176:191], v[20:23], v[208:211], v[176:191]
    ds_read_b128 v[56:59], v217 offset:32128
    v_exp_f32 v157, v157
    v_exp_f32 v158, v158
    v_exp_f32 v159, v159
    s_setprio 0
    v_exp_f32 v160, v160
    v_exp_f32 v161, v161
    v_smfmac_f32_32x32x32_bf16 v[192:207], v[40:43], v[152:159], v214
    ds_read_b32 v26, v216 offset:38656
    v_exp_f32 v162, v162
    v_exp_f32 v163, v163
    v_exp_f32 v164, v164
    s_waitcnt lgkmcnt(4)
    v_mfma_f32_32x32x4bf16_1k v[128:159], v[24:25], v[212:213], 0
    ds_read_b128 v[28:31], v217 offset:32768
    v_exp_f32 v165, v165
    v_exp_f32 v166, v166
    v_exp_f32 v167, v167
    v_exp_f32 v168, v168
    v_exp_f32 v169, v169
    v_exp_f32 v170, v170
    v_exp_f32 v171, v171
    v_exp_f32 v172, v172
    v_smfmac_f32_32x32x32_bf16 v[192:207], v[44:47], v[160:167], v214
    ds_read_b128 v[32:35], v217 offset:33408
    v_exp_f32 v173, v173
    v_exp_f32 v174, v174
    v_exp_f32 v175, v175
    v_exp_f32 v176, v176
    v_exp_f32 v177, v177
    v_smfmac_f32_32x32x32_bf16 v[192:207], v[48:51], v[168:175], v214
    ds_read_b128 v[16:19], v215 offset:25600
    v_exp_f32 v178, v178
    v_exp_f32 v179, v179
    v_exp_f32 v180, v180
    v_exp_f32 v181, v181
    v_mfma_f32_32x32x16_bf16 v[128:143], v[8:11], v[208:211], v[128:143]
    ds_read_b128 v[36:39], v217 offset:34048
    v_exp_f32 v182, v182
    v_exp_f32 v183, v183
    v_exp_f32 v184, v184
    v_exp_f32 v185, v185
    s_waitcnt lgkmcnt(5)
    v_smfmac_f32_32x32x32_bf16 v[192:207], v[52:55], v[176:183], v214
    ds_read_b128 v[20:23], v215 offset:26624
    v_exp_f32 v186, v186
    v_exp_f32 v187, v187
    v_exp_f32 v188, v188
    v_mfma_f32_32x32x16_bf16 v[144:159], v[12:15], v[208:211], v[144:159]
    ds_read_b128 v[40:43], v217 offset:34688
    v_exp_f32 v189, v189
    v_exp_f32 v190, v190
    v_exp_f32 v191, v191
    s_waitcnt vmcnt(0)
    s_barrier
    s_setprio 3
    v_exp_f32 v128, v128
    v_exp_f32 v129, v129
    v_smfmac_f32_32x32x32_bf16 v[192:207], v[56:59], v[184:191], v214
    ds_read_b32 v24, v216 offset:57344
    v_exp_f32 v130, v130
    v_exp_f32 v131, v131
    v_exp_f32 v132, v132
    s_waitcnt lgkmcnt(4)
    v_mfma_f32_32x32x4bf16_1k v[160:191], v[26:27], v[212:213], 0
    ds_read_b128 v[44:47], v217 offset:35328
    s_add_u32 m0, s83, 36864
    s_add_u32 s86, s84, 36864
    buffer_load_dwordx4 v218, s[4:7], s86 offen sc1  lds
    v_exp_f32 v133, v133
    v_exp_f32 v134, v134
    v_exp_f32 v135, v135
    v_exp_f32 v136, v136
    v_exp_f32 v137, v137
    v_exp_f32 v138, v138
    v_exp_f32 v139, v139
    v_exp_f32 v140, v140
    v_smfmac_f32_32x32x32_bf16 v[192:207], v[28:31], v[128:135], v214
    ds_read_b128 v[48:51], v217 offset:35968
    v_exp_f32 v141, v141
    v_exp_f32 v142, v142
    v_exp_f32 v143, v143
    v_exp_f32 v144, v144
    v_exp_f32 v145, v145
    v_smfmac_f32_32x32x32_bf16 v[192:207], v[32:35], v[136:143], v214
    ds_read_b128 v[8:11], v215 offset:38912
    v_exp_f32 v146, v146
    v_exp_f32 v147, v147
    v_exp_f32 v148, v148
    v_exp_f32 v149, v149
    v_mfma_f32_32x32x16_bf16 v[160:175], v[16:19], v[208:211], v[160:175]
    ds_read_b128 v[52:55], v217 offset:36608
    s_add_u32 m0, s83, 45056
    s_add_u32 s86, s84, 45056
    buffer_load_dwordx4 v218, s[4:7], s86 offen sc1  lds
    v_exp_f32 v150, v150
    v_exp_f32 v151, v151
    v_exp_f32 v152, v152
    v_exp_f32 v153, v153
    s_waitcnt lgkmcnt(5)
    v_smfmac_f32_32x32x32_bf16 v[192:207], v[36:39], v[144:151], v214
    ds_read_b128 v[12:15], v215 offset:39936
    v_exp_f32 v154, v154
    v_exp_f32 v155, v155
    v_exp_f32 v156, v156
    v_mfma_f32_32x32x16_bf16 v[176:191], v[20:23], v[208:211], v[176:191]
    ds_read_b128 v[56:59], v217 offset:37248
    v_exp_f32 v157, v157
    v_exp_f32 v158, v158
    v_exp_f32 v159, v159
    s_setprio 2
    v_exp_f32 v160, v160
    v_exp_f32 v161, v161
    v_smfmac_f32_32x32x32_bf16 v[192:207], v[40:43], v[152:159], v214
    ds_read_b32 v26, v216 offset:57600
    v_exp_f32 v162, v162
    v_exp_f32 v163, v163
    v_exp_f32 v164, v164
    s_waitcnt lgkmcnt(4)
    v_mfma_f32_32x32x4bf16_1k v[128:159], v[24:25], v[212:213], 0
    ds_read_b128 v[28:31], v217 offset:47104
    s_cmp_ge_u32 s26, 3
    s_cbranch_scc1 L_74
    s_add_u32 m0, s83, 53248
    s_add_u32 s86, s84, 53248
    buffer_load_dwordx4 v218, s[4:7], s86 offen sc1  lds
L_74:
    v_exp_f32 v165, v165
    v_exp_f32 v166, v166
    v_exp_f32 v167, v167
    v_exp_f32 v168, v168
    v_exp_f32 v169, v169
    v_exp_f32 v170, v170
    v_exp_f32 v171, v171
    v_exp_f32 v172, v172
    v_smfmac_f32_32x32x32_bf16 v[192:207], v[44:47], v[160:167], v214
    ds_read_b128 v[32:35], v217 offset:47744
    v_exp_f32 v173, v173
    v_exp_f32 v174, v174
    v_exp_f32 v175, v175
    v_exp_f32 v176, v176
    v_exp_f32 v177, v177
    v_smfmac_f32_32x32x32_bf16 v[192:207], v[48:51], v[168:175], v214
    ds_read_b128 v[16:19], v215 offset:40960
    v_exp_f32 v178, v178
    v_exp_f32 v179, v179
    v_exp_f32 v180, v180
    v_exp_f32 v181, v181
    v_mfma_f32_32x32x16_bf16 v[128:143], v[8:11], v[208:211], v[128:143]
    ds_read_b128 v[36:39], v217 offset:48384
    v_exp_f32 v182, v182
    v_exp_f32 v183, v183
    v_exp_f32 v184, v184
    v_exp_f32 v185, v185
    s_waitcnt lgkmcnt(5)
    v_smfmac_f32_32x32x32_bf16 v[192:207], v[52:55], v[176:183], v214
    ds_read_b128 v[20:23], v215 offset:41984
    v_exp_f32 v186, v186
    v_exp_f32 v187, v187
    v_exp_f32 v188, v188
    v_mfma_f32_32x32x16_bf16 v[144:159], v[12:15], v[208:211], v[144:159]
    ds_read_b128 v[40:43], v217 offset:49024
    v_exp_f32 v189, v189
    v_exp_f32 v190, v190
    v_exp_f32 v191, v191
    s_setprio 2
    v_exp_f32 v128, v128
    v_exp_f32 v129, v129
    v_smfmac_f32_32x32x32_bf16 v[192:207], v[56:59], v[184:191], v214
    ds_read_b32 v24, v216 offset:57856
    v_exp_f32 v130, v130
    v_exp_f32 v131, v131
    v_exp_f32 v132, v132
    s_waitcnt lgkmcnt(4)
    v_mfma_f32_32x32x4bf16_1k v[160:191], v[26:27], v[212:213], 0
    ds_read_b128 v[44:47], v217 offset:49664
    v_exp_f32 v133, v133
    v_exp_f32 v134, v134
    v_exp_f32 v135, v135
    v_exp_f32 v136, v136
    v_exp_f32 v137, v137
    v_exp_f32 v138, v138
    v_exp_f32 v139, v139
    v_exp_f32 v140, v140
    v_smfmac_f32_32x32x32_bf16 v[192:207], v[28:31], v[128:135], v214
    ds_read_b128 v[48:51], v217 offset:50304
    v_exp_f32 v141, v141
    v_exp_f32 v142, v142
    v_exp_f32 v143, v143
    v_exp_f32 v144, v144
    v_exp_f32 v145, v145
    v_smfmac_f32_32x32x32_bf16 v[192:207], v[32:35], v[136:143], v214
    ds_read_b128 v[8:11], v215 offset:43008
    v_exp_f32 v146, v146
    v_exp_f32 v147, v147
    v_exp_f32 v148, v148
    v_exp_f32 v149, v149
    v_mfma_f32_32x32x16_bf16 v[160:175], v[16:19], v[208:211], v[160:175]
    ds_read_b128 v[52:55], v217 offset:50944
    v_exp_f32 v150, v150
    v_exp_f32 v151, v151
    v_exp_f32 v152, v152
    v_exp_f32 v153, v153
    s_waitcnt lgkmcnt(5)
    v_smfmac_f32_32x32x32_bf16 v[192:207], v[36:39], v[144:151], v214
    ds_read_b128 v[12:15], v215 offset:44032
    v_exp_f32 v154, v154
    v_exp_f32 v155, v155
    v_exp_f32 v156, v156
    v_mfma_f32_32x32x16_bf16 v[176:191], v[20:23], v[208:211], v[176:191]
    ds_read_b128 v[56:59], v217 offset:51584
    v_exp_f32 v157, v157
    v_exp_f32 v158, v158
    v_exp_f32 v159, v159
    s_setprio 1
    v_exp_f32 v160, v160
    v_exp_f32 v161, v161
    v_smfmac_f32_32x32x32_bf16 v[192:207], v[40:43], v[152:159], v214
    ds_read_b32 v26, v216 offset:58112
    v_exp_f32 v162, v162
    v_exp_f32 v163, v163
    v_exp_f32 v164, v164
    s_waitcnt lgkmcnt(4)
    v_mfma_f32_32x32x4bf16_1k v[128:159], v[24:25], v[212:213], 0
    ds_read_b128 v[28:31], v217 offset:52224
    v_exp_f32 v165, v165
    v_exp_f32 v166, v166
    v_exp_f32 v167, v167
    v_exp_f32 v168, v168
    v_exp_f32 v169, v169
    v_exp_f32 v170, v170
    v_exp_f32 v171, v171
    v_exp_f32 v172, v172
    v_smfmac_f32_32x32x32_bf16 v[192:207], v[44:47], v[160:167], v214
    ds_read_b128 v[32:35], v217 offset:52864
    v_exp_f32 v173, v173
    v_exp_f32 v174, v174
    v_exp_f32 v175, v175
    v_exp_f32 v176, v176
    v_exp_f32 v177, v177
    v_smfmac_f32_32x32x32_bf16 v[192:207], v[48:51], v[168:175], v214
    ds_read_b128 v[16:19], v215 offset:45056
    v_exp_f32 v178, v178
    v_exp_f32 v179, v179
    v_exp_f32 v180, v180
    v_exp_f32 v181, v181
    v_mfma_f32_32x32x16_bf16 v[128:143], v[8:11], v[208:211], v[128:143]
    ds_read_b128 v[36:39], v217 offset:53504
    v_exp_f32 v182, v182
    v_exp_f32 v183, v183
    v_exp_f32 v184, v184
    v_exp_f32 v185, v185
    s_waitcnt lgkmcnt(5)
    v_smfmac_f32_32x32x32_bf16 v[192:207], v[52:55], v[176:183], v214
    ds_read_b128 v[20:23], v215 offset:46080
    v_exp_f32 v186, v186
    v_exp_f32 v187, v187
    v_exp_f32 v188, v188
    v_mfma_f32_32x32x16_bf16 v[144:159], v[12:15], v[208:211], v[144:159]
    ds_read_b128 v[40:43], v217 offset:54144
    v_exp_f32 v189, v189
    v_exp_f32 v190, v190
    v_exp_f32 v191, v191
    s_setprio 1
    v_exp_f32 v128, v128
    v_exp_f32 v129, v129
    v_smfmac_f32_32x32x32_bf16 v[192:207], v[56:59], v[184:191], v214
    v_exp_f32 v130, v130
    v_exp_f32 v131, v131
    v_exp_f32 v132, v132
    s_waitcnt lgkmcnt(3)
    v_mfma_f32_32x32x4bf16_1k v[160:191], v[26:27], v[212:213], 0
    ds_read_b128 v[44:47], v217 offset:54784
    v_exp_f32 v133, v133
    v_exp_f32 v134, v134
    v_exp_f32 v135, v135
    v_exp_f32 v136, v136
    v_exp_f32 v137, v137
    v_exp_f32 v138, v138
    v_exp_f32 v139, v139
    v_exp_f32 v140, v140
    v_smfmac_f32_32x32x32_bf16 v[192:207], v[28:31], v[128:135], v214
    ds_read_b128 v[48:51], v217 offset:55424
    v_exp_f32 v141, v141
    v_exp_f32 v142, v142
    v_exp_f32 v143, v143
    v_exp_f32 v144, v144
    v_exp_f32 v145, v145
    v_smfmac_f32_32x32x32_bf16 v[192:207], v[32:35], v[136:143], v214
    v_exp_f32 v146, v146
    v_exp_f32 v147, v147
    v_exp_f32 v148, v148
    v_exp_f32 v149, v149
    v_mfma_f32_32x32x16_bf16 v[160:175], v[16:19], v[208:211], v[160:175]
    ds_read_b128 v[52:55], v217 offset:56064
    v_exp_f32 v150, v150
    v_exp_f32 v151, v151
    v_exp_f32 v152, v152
    v_exp_f32 v153, v153
    s_waitcnt lgkmcnt(3)
    v_smfmac_f32_32x32x32_bf16 v[192:207], v[36:39], v[144:151], v214
    v_exp_f32 v154, v154
    v_exp_f32 v155, v155
    v_exp_f32 v156, v156
    v_mfma_f32_32x32x16_bf16 v[176:191], v[20:23], v[208:211], v[176:191]
    ds_read_b128 v[56:59], v217 offset:56704
    v_exp_f32 v157, v157
    v_exp_f32 v158, v158
    v_exp_f32 v159, v159
    s_setprio 0
    v_exp_f32 v160, v160
    v_exp_f32 v161, v161
    v_smfmac_f32_32x32x32_bf16 v[192:207], v[40:43], v[152:159], v214
    v_exp_f32 v162, v162
    v_exp_f32 v163, v163
    v_exp_f32 v164, v164
    s_waitcnt lgkmcnt(2)
    v_exp_f32 v165, v165
    v_exp_f32 v166, v166
    v_exp_f32 v167, v167
    v_exp_f32 v168, v168
    v_exp_f32 v169, v169
    v_exp_f32 v170, v170
    v_exp_f32 v171, v171
    v_exp_f32 v172, v172
    v_smfmac_f32_32x32x32_bf16 v[192:207], v[44:47], v[160:167], v214
    v_exp_f32 v173, v173
    v_exp_f32 v174, v174
    v_exp_f32 v175, v175
    v_exp_f32 v176, v176
    v_exp_f32 v177, v177
    v_smfmac_f32_32x32x32_bf16 v[192:207], v[48:51], v[168:175], v214
    v_exp_f32 v178, v178
    v_exp_f32 v179, v179
    v_exp_f32 v180, v180
    v_exp_f32 v181, v181
    v_exp_f32 v182, v182
    v_exp_f32 v183, v183
    v_exp_f32 v184, v184
    v_exp_f32 v185, v185
    s_waitcnt lgkmcnt(0)
    v_smfmac_f32_32x32x32_bf16 v[192:207], v[52:55], v[176:183], v214
    v_exp_f32 v186, v186
    v_exp_f32 v187, v187
    v_exp_f32 v188, v188
    v_exp_f32 v189, v189
    v_exp_f32 v190, v190
    v_exp_f32 v191, v191
    s_nop 1
    v_smfmac_f32_32x32x32_bf16 v[192:207], v[56:59], v[184:191], v214
    s_setprio 0
    s_add_u32 s60, s71, s25
    s_lshl_b32 s60, s60, 6
    s_add_u32 s70, s60, 335872
    s_lshl_b32 s61, s71, 6
    s_add_u32 s83, s61, 335872
    s_mov_b32 s72, 0
L_att_norm:
    s_nop 5
    v_mov_b32 v10, v202
    v_mov_b32 v11, v202
    v_add_f32 v12, abs(v192), abs(v193)
    v_add_f32 v13, abs(v194), abs(v195)
    v_permlane32_swap_b32 v10, v11
    v_add_f32 v12, v12, abs(v196)
    v_add_f32 v13, v13, abs(v197)
    v_add_f32 v12, v12, abs(v198)
    v_add_f32 v13, v13, abs(v199)
    v_add_f32 v12, v12, abs(v200)
    v_add_f32 v13, v13, abs(v201)
    v_add_f32 v12, v12, v13
    v_rcp_f32 v11, v10
    v_cmp_le_f32 vcc, 0x0d800000, v10
    v_cmp_ge_f32 s[94:95], s73, v10
    v_cmp_ge_f32 s[100:101], s74, v12
    s_nop 0
    s_and_b64 vcc, vcc, s[94:95]
    s_and_b64 vcc, vcc, s[100:101]
    s_cmp_eq_u64 vcc, exec
    s_cbranch_scc1 L_att_ok
    s_cmp_eq_u32 s72, 0
    s_cbranch_scc1 L_att_fallback
L_att_ok:
    v_mul_f32 v192, v11, v192
    v_mul_f32 v193, v11, v193
    v_mul_f32 v194, v11, v194
    v_mul_f32 v195, v11, v195
    v_mul_f32 v196, v11, v196
    v_mul_f32 v197, v11, v197
    v_mul_f32 v198, v11, v198
    v_mul_f32 v199, v11, v199
    v_mul_f32 v200, v11, v200
    v_mul_f32 v201, v11, v201
    v_cvt_pk_bf16_f32 v12, v192, v193
    v_cvt_pk_bf16_f32 v13, v194, v195
    v_cvt_pk_bf16_f32 v14, v196, v197
    v_cvt_pk_bf16_f32 v15, v198, v199
    v_cvt_pk_bf16_f32 v16, v200, v201
    buffer_store_dwordx4 v[12:15], v225, s[4:7], s81 offen sc1
    s_mov_b32 exec_hi, 0
    buffer_store_dword v16, v226, s[4:7], s82 offen sc1
    s_mov_b64 exec, -1
    s_cmp_lg_u32 s26, 0
    s_waitcnt vmcnt(0)
    s_barrier
    s_cbranch_scc1 L_op_nf
    s_mov_b64 exec, 1
    buffer_store_dwordx2 v[222:223], v224, s[4:7], s70 offen sc1
    s_mov_b64 exec, -1
L_op_nf:
    s_cmp_ge_u32 s26, 4
    s_cbranch_scc1 L_op_help
    s_mov_b32 s63, 0xffff0000
    v_lshlrev_b32 v96, 16, v76
    v_and_b32 v97, s63, v76
    v_lshlrev_b32 v116, 16, v86
    v_and_b32 v117, s63, v86
    v_lshlrev_b32 v98, 16, v77
    v_and_b32 v99, s63, v77
    v_lshlrev_b32 v118, 16, v87
    v_and_b32 v119, s63, v87
    v_lshlrev_b32 v100, 16, v78
    v_and_b32 v101, s63, v78
    v_lshlrev_b32 v120, 16, v88
    v_and_b32 v121, s63, v88
    v_lshlrev_b32 v102, 16, v79
    v_and_b32 v103, s63, v79
    v_lshlrev_b32 v122, 16, v89
    v_and_b32 v123, s63, v89
    v_lshlrev_b32 v104, 16, v80
    v_and_b32 v105, s63, v80
    v_lshlrev_b32 v124, 16, v90
    v_and_b32 v125, s63, v90
    v_lshlrev_b32 v106, 16, v81
    v_and_b32 v107, s63, v81
    v_lshlrev_b32 v126, 16, v91
    v_and_b32 v127, s63, v91
    v_lshlrev_b32 v108, 16, v82
    v_and_b32 v109, s63, v82
    v_lshlrev_b32 v240, 16, v92
    v_and_b32 v241, s63, v92
    v_lshlrev_b32 v110, 16, v83
    v_and_b32 v111, s63, v83
    v_lshlrev_b32 v242, 16, v93
    v_and_b32 v243, s63, v93
    v_lshlrev_b32 v112, 16, v84
    v_and_b32 v113, s63, v84
    v_lshlrev_b32 v244, 16, v94
    v_and_b32 v245, s63, v94
    v_lshlrev_b32 v114, 16, v85
    v_and_b32 v115, s63, v85
    v_lshlrev_b32 v246, 16, v95
    v_and_b32 v247, s63, v95
    s_mov_b32 s8, s50
    s_mov_b32 s9, s51
    s_mov_b32 s10, 2359296
    s_mov_b32 s11, 0x20000
    s_lshl_b32 s60, s24, 8
    v_add_u32 v72, s60, v62
    v_mul_u32_u24 v72, 1152, v72
    v_lshl_add_u32 v73, v61, 3, v72
    v_lshl_add_u32 v72, v61, 4, v72
    v_mov_b32 v4, 0x7fffffff
    v_cmp_gt_u32 vcc, 2, v61
    s_mul_i32 s78, s65, 144
    s_nop 0
    v_cndmask_b32 v73, v4, v73, vcc
    s_cmp_lg_u32 s26, 0
    s_cbranch_scc1 L_75
    s_waitcnt vmcnt(0)
    s_mov_b32 s96, 400000
    s_mov_b64 exec, 1
Lp1_78:
    buffer_load_dwordx2 v[56:57], v71, s[4:7], s83 offen offset:0 sc1
    s_waitcnt vmcnt(0)
    v_cmp_eq_u64 vcc, s[28:29], v[56:57]
    s_nop 0
    s_cmp_lg_u64 vcc, 0
    s_cbranch_scc1 Lp1d_79
    s_sleep 2
    s_sub_u32 s96, s96, 1
    s_cmp_gt_u32 s96, 1
    s_cbranch_scc1 Lp1_78
Lp1d_79:
    s_mov_b64 exec, -1
Lpoll_76:
    buffer_load_dwordx2 v[56:57], v71, s[4:7], s83 offen offset:0 sc1
    s_waitcnt vmcnt(0)
    v_cmp_ne_u64 vcc, s[28:29], v[56:57]
    s_nop 0
    s_cmp_eq_u64 vcc, 0
    s_cbranch_scc1 Lpolld_77
    s_mov_b64 exec, vcc
    s_sleep 4
    s_sub_u32 s96, s96, 1
    s_cmp_lg_u32 s96, 0
    s_cbranch_scc1 Lpoll_76
    v_mov_b32 v56, 6
    v_mov_b32 v57, 0
    global_store_dword v57, v56, s[52:53]
    s_waitcnt vmcnt(0)
Lpolld_77:
    s_mov_b64 exec, -1
L_75:
    s_barrier
    s_lshl_b32 s60, s71, 13
    s_add_u32 s60, s60, 28311552
    s_lshl_b32 s61, s71, 10
    s_add_u32 s61, s61, 32505856
    buffer_load_dwordx4 v[128:131], v65, s[4:7], s60 offen sc1
    s_add_u32 s60, s60, 0x4000
    buffer_load_dwordx4 v[132:135], v65, s[4:7], s60 offen sc1
    s_add_u32 s60, s60, 0x4000
    buffer_load_dwordx4 v[136:139], v65, s[4:7], s60 offen sc1
    s_add_u32 s60, s60, 0x4000
    buffer_load_dwordx4 v[140:143], v65, s[4:7], s60 offen sc1
    s_add_u32 s60, s60, 0x4000
    buffer_load_dwordx4 v[144:147], v65, s[4:7], s60 offen sc1
    s_add_u32 s60, s60, 0x4000
    buffer_load_dwordx4 v[148:151], v65, s[4:7], s60 offen sc1
    s_add_u32 s60, s60, 0x4000
    buffer_load_dwordx4 v[152:155], v65, s[4:7], s60 offen sc1
    s_add_u32 s60, s60, 0x4000
    buffer_load_dwordx4 v[156:159], v65, s[4:7], s60 offen sc1
    s_add_u32 s60, s60, 0x4000
    buffer_load_dwordx4 v[160:163], v65, s[4:7], s60 offen sc1
    s_add_u32 s60, s60, 0x4000
    buffer_load_dwordx4 v[164:167], v65, s[4:7], s60 offen sc1
    s_add_u32 s60, s60, 0x4000
    buffer_load_dwordx4 v[168:171], v65, s[4:7], s60 offen sc1
    s_add_u32 s60, s60, 0x4000
    buffer_load_dwordx4 v[172:175], v65, s[4:7], s60 offen sc1
    s_add_u32 s60, s60, 0x4000
    buffer_load_dwordx4 v[176:179], v65, s[4:7], s60 offen sc1
    s_add_u32 s60, s60, 0x4000
    buffer_load_dwordx4 v[180:183], v65, s[4:7], s60 offen sc1
    s_add_u32 s60, s60, 0x4000
    buffer_load_dwordx4 v[184:187], v65, s[4:7], s60 offen sc1
    s_add_u32 s60, s60, 0x4000
    buffer_load_dwordx4 v[188:191], v65, s[4:7], s60 offen sc1
    buffer_load_dword v192, v66, s[4:7], s61 offen offset:0 sc1
    buffer_load_dword v193, v66, s[4:7], s61 offen offset:1024 sc1
    buffer_load_dword v194, v66, s[4:7], s61 offen offset:2048 sc1
    buffer_load_dword v195, v66, s[4:7], s61 offen offset:3072 sc1
    s_add_u32 s61, s61, 0x4000
    buffer_load_dword v196, v66, s[4:7], s61 offen offset:0 sc1
    buffer_load_dword v197, v66, s[4:7], s61 offen offset:1024 sc1
    buffer_load_dword v198, v66, s[4:7], s61 offen offset:2048 sc1
    buffer_load_dword v199, v66, s[4:7], s61 offen offset:3072 sc1
    ds_read_b128 v[36:39], v67 offset:0
    ds_read_b128 v[40:43], v67 offset:1024
    ds_read_b128 v[44:47], v67 offset:2048
    ds_read_b128 v[48:51], v67 offset:3072
    ds_read_b128 v[52:55], v68 offset:0
    ds_read_b128 v[200:203], v67 offset:4608
    ds_read_b128 v[204:207], v67 offset:5632
    ds_read_b128 v[208:211], v67 offset:6656
    ds_read_b128 v[212:215], v67 offset:7680
    ds_read_b128 v[216:219], v68 offset:4608
    s_waitcnt vmcnt(23) lgkmcnt(5)
    v_mfma_f32_16x16x32_bf16 v[16:19], v[36:39], v[128:131], v[96:99]
    ds_read_b128 v[220:223], v67 offset:9216
    v_mfma_f32_16x16x32_bf16 v[20:23], v[40:43], v[128:131], v[100:103]
    ds_read_b128 v[224:227], v67 offset:10240
    v_mfma_f32_16x16x32_bf16 v[24:27], v[44:47], v[128:131], v[104:107]
    ds_read_b128 v[228:231], v67 offset:11264
    v_mfma_f32_16x16x32_bf16 v[28:31], v[48:51], v[128:131], v[108:111]
    ds_read_b128 v[232:235], v67 offset:12288
    v_mfma_f32_16x16x32_bf16 v[32:35], v[52:55], v[128:131], v[112:115]
    ds_read_b128 v[236:239], v68 offset:9216
    s_waitcnt vmcnt(22) lgkmcnt(5)
    v_mfma_f32_16x16x32_bf16 v[16:19], v[200:203], v[132:135], v[16:19]
    ds_read_b128 v[36:39], v67 offset:13824
    v_mfma_f32_16x16x32_bf16 v[20:23], v[204:207], v[132:135], v[20:23]
    ds_read_b128 v[40:43], v67 offset:14848
    v_mfma_f32_16x16x32_bf16 v[24:27], v[208:211], v[132:135], v[24:27]
    ds_read_b128 v[44:47], v67 offset:15872
    v_mfma_f32_16x16x32_bf16 v[28:31], v[212:215], v[132:135], v[28:31]
    ds_read_b128 v[48:51], v67 offset:16896
    v_mfma_f32_16x16x32_bf16 v[32:35], v[216:219], v[132:135], v[32:35]
    ds_read_b128 v[52:55], v68 offset:13824
    s_waitcnt vmcnt(21) lgkmcnt(5)
    v_mfma_f32_16x16x32_bf16 v[16:19], v[220:223], v[136:139], v[16:19]
    ds_read_b128 v[200:203], v67 offset:18432
    v_mfma_f32_16x16x32_bf16 v[20:23], v[224:227], v[136:139], v[20:23]
    ds_read_b128 v[204:207], v67 offset:19456
    v_mfma_f32_16x16x32_bf16 v[24:27], v[228:231], v[136:139], v[24:27]
    ds_read_b128 v[208:211], v67 offset:20480
    v_mfma_f32_16x16x32_bf16 v[28:31], v[232:235], v[136:139], v[28:31]
    ds_read_b128 v[212:215], v67 offset:21504
    v_mfma_f32_16x16x32_bf16 v[32:35], v[236:239], v[136:139], v[32:35]
    ds_read_b128 v[216:219], v68 offset:18432
    s_waitcnt vmcnt(20) lgkmcnt(5)
    v_mfma_f32_16x16x32_bf16 v[16:19], v[36:39], v[140:143], v[16:19]
    ds_read_b128 v[220:223], v67 offset:23040
    v_mfma_f32_16x16x32_bf16 v[20:23], v[40:43], v[140:143], v[20:23]
    ds_read_b128 v[224:227], v67 offset:24064
    v_mfma_f32_16x16x32_bf16 v[24:27], v[44:47], v[140:143], v[24:27]
    ds_read_b128 v[228:231], v67 offset:25088
    v_mfma_f32_16x16x32_bf16 v[28:31], v[48:51], v[140:143], v[28:31]
    ds_read_b128 v[232:235], v67 offset:26112
    v_mfma_f32_16x16x32_bf16 v[32:35], v[52:55], v[140:143], v[32:35]
    ds_read_b128 v[236:239], v68 offset:23040
    s_waitcnt vmcnt(19) lgkmcnt(5)
    v_mfma_f32_16x16x32_bf16 v[16:19], v[200:203], v[144:147], v[16:19]
    ds_read_b128 v[36:39], v67 offset:27648
    v_mfma_f32_16x16x32_bf16 v[20:23], v[204:207], v[144:147], v[20:23]
    ds_read_b128 v[40:43], v67 offset:28672
    v_mfma_f32_16x16x32_bf16 v[24:27], v[208:211], v[144:147], v[24:27]
    ds_read_b128 v[44:47], v67 offset:29696
    v_mfma_f32_16x16x32_bf16 v[28:31], v[212:215], v[144:147], v[28:31]
    ds_read_b128 v[48:51], v67 offset:30720
    v_mfma_f32_16x16x32_bf16 v[32:35], v[216:219], v[144:147], v[32:35]
    ds_read_b128 v[52:55], v68 offset:27648
    s_waitcnt vmcnt(18) lgkmcnt(5)
    v_mfma_f32_16x16x32_bf16 v[16:19], v[220:223], v[148:151], v[16:19]
    ds_read_b128 v[200:203], v67 offset:32256
    v_mfma_f32_16x16x32_bf16 v[20:23], v[224:227], v[148:151], v[20:23]
    ds_read_b128 v[204:207], v67 offset:33280
    v_mfma_f32_16x16x32_bf16 v[24:27], v[228:231], v[148:151], v[24:27]
    ds_read_b128 v[208:211], v67 offset:34304
    v_mfma_f32_16x16x32_bf16 v[28:31], v[232:235], v[148:151], v[28:31]
    ds_read_b128 v[212:215], v67 offset:35328
    v_mfma_f32_16x16x32_bf16 v[32:35], v[236:239], v[148:151], v[32:35]
    ds_read_b128 v[216:219], v68 offset:32256
    s_waitcnt vmcnt(17) lgkmcnt(5)
    v_mfma_f32_16x16x32_bf16 v[16:19], v[36:39], v[152:155], v[16:19]
    ds_read_b128 v[220:223], v67 offset:36864
    v_mfma_f32_16x16x32_bf16 v[20:23], v[40:43], v[152:155], v[20:23]
    ds_read_b128 v[224:227], v67 offset:37888
    v_mfma_f32_16x16x32_bf16 v[24:27], v[44:47], v[152:155], v[24:27]
    ds_read_b128 v[228:231], v67 offset:38912
    v_mfma_f32_16x16x32_bf16 v[28:31], v[48:51], v[152:155], v[28:31]
    ds_read_b128 v[232:235], v67 offset:39936
    v_mfma_f32_16x16x32_bf16 v[32:35], v[52:55], v[152:155], v[32:35]
    ds_read_b128 v[236:239], v68 offset:36864
    s_waitcnt vmcnt(16) lgkmcnt(5)
    v_mfma_f32_16x16x32_bf16 v[16:19], v[200:203], v[156:159], v[16:19]
    ds_read_b128 v[36:39], v69 offset:0
    v_mfma_f32_16x16x32_bf16 v[20:23], v[204:207], v[156:159], v[20:23]
    ds_read_b128 v[40:43], v69 offset:1024
    v_mfma_f32_16x16x32_bf16 v[24:27], v[208:211], v[156:159], v[24:27]
    ds_read_b128 v[44:47], v69 offset:2048
    v_mfma_f32_16x16x32_bf16 v[28:31], v[212:215], v[156:159], v[28:31]
    ds_read_b128 v[48:51], v69 offset:3072
    v_mfma_f32_16x16x32_bf16 v[32:35], v[216:219], v[156:159], v[32:35]
    ds_read_b128 v[52:55], v70 offset:0
    s_waitcnt vmcnt(15) lgkmcnt(5)
    v_mfma_f32_16x16x32_bf16 v[16:19], v[220:223], v[160:163], v[16:19]
    ds_read_b128 v[200:203], v69 offset:4608
    v_mfma_f32_16x16x32_bf16 v[20:23], v[224:227], v[160:163], v[20:23]
    ds_read_b128 v[204:207], v69 offset:5632
    v_mfma_f32_16x16x32_bf16 v[24:27], v[228:231], v[160:163], v[24:27]
    ds_read_b128 v[208:211], v69 offset:6656
    v_mfma_f32_16x16x32_bf16 v[28:31], v[232:235], v[160:163], v[28:31]
    ds_read_b128 v[212:215], v69 offset:7680
    v_mfma_f32_16x16x32_bf16 v[32:35], v[236:239], v[160:163], v[32:35]
    ds_read_b128 v[216:219], v70 offset:4608
    s_waitcnt vmcnt(14) lgkmcnt(5)
    v_mfma_f32_16x16x32_bf16 v[16:19], v[36:39], v[164:167], v[16:19]
    ds_read_b128 v[220:223], v69 offset:9216
    v_mfma_f32_16x16x32_bf16 v[20:23], v[40:43], v[164:167], v[20:23]
    ds_read_b128 v[224:227], v69 offset:10240
    v_mfma_f32_16x16x32_bf16 v[24:27], v[44:47], v[164:167], v[24:27]
    ds_read_b128 v[228:231], v69 offset:11264
    v_mfma_f32_16x16x32_bf16 v[28:31], v[48:51], v[164:167], v[28:31]
    ds_read_b128 v[232:235], v69 offset:12288
    v_mfma_f32_16x16x32_bf16 v[32:35], v[52:55], v[164:167], v[32:35]
    ds_read_b128 v[236:239], v70 offset:9216
    s_waitcnt vmcnt(13) lgkmcnt(5)
    v_mfma_f32_16x16x32_bf16 v[16:19], v[200:203], v[168:171], v[16:19]
    ds_read_b128 v[36:39], v69 offset:13824
    v_mfma_f32_16x16x32_bf16 v[20:23], v[204:207], v[168:171], v[20:23]
    ds_read_b128 v[40:43], v69 offset:14848
    v_mfma_f32_16x16x32_bf16 v[24:27], v[208:211], v[168:171], v[24:27]
    ds_read_b128 v[44:47], v69 offset:15872
    v_mfma_f32_16x16x32_bf16 v[28:31], v[212:215], v[168:171], v[28:31]
    ds_read_b128 v[48:51], v69 offset:16896
    v_mfma_f32_16x16x32_bf16 v[32:35], v[216:219], v[168:171], v[32:35]
    ds_read_b128 v[52:55], v70 offset:13824
    s_waitcnt vmcnt(12) lgkmcnt(5)
    v_mfma_f32_16x16x32_bf16 v[16:19], v[220:223], v[172:175], v[16:19]
    ds_read_b128 v[200:203], v69 offset:18432
    v_mfma_f32_16x16x32_bf16 v[20:23], v[224:227], v[172:175], v[20:23]
    ds_read_b128 v[204:207], v69 offset:19456
    v_mfma_f32_16x16x32_bf16 v[24:27], v[228:231], v[172:175], v[24:27]
    ds_read_b128 v[208:211], v69 offset:20480
    v_mfma_f32_16x16x32_bf16 v[28:31], v[232:235], v[172:175], v[28:31]
    ds_read_b128 v[212:215], v69 offset:21504
    v_mfma_f32_16x16x32_bf16 v[32:35], v[236:239], v[172:175], v[32:35]
    ds_read_b128 v[216:219], v70 offset:18432
    s_waitcnt vmcnt(11) lgkmcnt(5)
    v_mfma_f32_16x16x32_bf16 v[16:19], v[36:39], v[176:179], v[16:19]
    ds_read_b128 v[220:223], v69 offset:23040
    v_mfma_f32_16x16x32_bf16 v[20:23], v[40:43], v[176:179], v[20:23]
    ds_read_b128 v[224:227], v69 offset:24064
    v_mfma_f32_16x16x32_bf16 v[24:27], v[44:47], v[176:179], v[24:27]
    ds_read_b128 v[228:231], v69 offset:25088
    v_mfma_f32_16x16x32_bf16 v[28:31], v[48:51], v[176:179], v[28:31]
    ds_read_b128 v[232:235], v69 offset:26112
    v_mfma_f32_16x16x32_bf16 v[32:35], v[52:55], v[176:179], v[32:35]
    ds_read_b128 v[236:239], v70 offset:23040
    s_waitcnt vmcnt(10) lgkmcnt(5)
    v_mfma_f32_16x16x32_bf16 v[16:19], v[200:203], v[180:183], v[16:19]
    ds_read_b128 v[36:39], v69 offset:27648
    v_mfma_f32_16x16x32_bf16 v[20:23], v[204:207], v[180:183], v[20:23]
    ds_read_b128 v[40:43], v69 offset:28672
    v_mfma_f32_16x16x32_bf16 v[24:27], v[208:211], v[180:183], v[24:27]
    ds_read_b128 v[44:47], v69 offset:29696
    v_mfma_f32_16x16x32_bf16 v[28:31], v[212:215], v[180:183], v[28:31]
    ds_read_b128 v[48:51], v69 offset:30720
    v_mfma_f32_16x16x32_bf16 v[32:35], v[216:219], v[180:183], v[32:35]
    ds_read_b128 v[52:55], v70 offset:27648
    s_waitcnt vmcnt(9) lgkmcnt(5)
    v_mfma_f32_16x16x32_bf16 v[16:19], v[220:223], v[184:187], v[16:19]
    ds_read_b128 v[200:203], v69 offset:32256
    v_mfma_f32_16x16x32_bf16 v[20:23], v[224:227], v[184:187], v[20:23]
    ds_read_b128 v[204:207], v69 offset:33280
    v_mfma_f32_16x16x32_bf16 v[24:27], v[228:231], v[184:187], v[24:27]
    ds_read_b128 v[208:211], v69 offset:34304
    v_mfma_f32_16x16x32_bf16 v[28:31], v[232:235], v[184:187], v[28:31]
    ds_read_b128 v[212:215], v69 offset:35328
    v_mfma_f32_16x16x32_bf16 v[32:35], v[236:239], v[184:187], v[32:35]
    ds_read_b128 v[216:219], v70 offset:32256
    s_waitcnt vmcnt(8) lgkmcnt(5)
    v_mfma_f32_16x16x32_bf16 v[16:19], v[36:39], v[188:191], v[16:19]
    ds_read_b128 v[220:223], v69 offset:36864
    v_mfma_f32_16x16x32_bf16 v[20:23], v[40:43], v[188:191], v[20:23]
    ds_read_b128 v[224:227], v69 offset:37888
    v_mfma_f32_16x16x32_bf16 v[24:27], v[44:47], v[188:191], v[24:27]
    ds_read_b128 v[228:231], v69 offset:38912
    v_mfma_f32_16x16x32_bf16 v[28:31], v[48:51], v[188:191], v[28:31]
    ds_read_b128 v[232:235], v69 offset:39936
    v_mfma_f32_16x16x32_bf16 v[32:35], v[52:55], v[188:191], v[32:35]
    ds_read_b128 v[236:239], v70 offset:36864
    s_waitcnt vmcnt(4) lgkmcnt(5)
    v_mfma_f32_16x16x32_bf16 v[16:19], v[200:203], v[192:195], v[16:19]
    v_mfma_f32_16x16x32_bf16 v[20:23], v[204:207], v[192:195], v[20:23]
    v_mfma_f32_16x16x32_bf16 v[24:27], v[208:211], v[192:195], v[24:27]
    v_mfma_f32_16x16x32_bf16 v[28:31], v[212:215], v[192:195], v[28:31]
    v_mfma_f32_16x16x32_bf16 v[32:35], v[216:219], v[192:195], v[32:35]
    s_waitcnt vmcnt(0) lgkmcnt(0)
    v_mfma_f32_16x16x32_bf16 v[16:19], v[220:223], v[196:199], v[16:19]
    v_mfma_f32_16x16x32_bf16 v[20:23], v[224:227], v[196:199], v[20:23]
    v_mfma_f32_16x16x32_bf16 v[24:27], v[228:231], v[196:199], v[24:27]
    v_mfma_f32_16x16x32_bf16 v[28:31], v[232:235], v[196:199], v[28:31]
    v_mfma_f32_16x16x32_bf16 v[32:35], v[236:239], v[196:199], v[32:35]
    s_lshl_b32 s60, s24, 2
    s_add_u32 s60, s60, s64
    s_lshl_b32 s60, s60, 13
    s_add_u32 s60, s60, 458752
    s_lshl_b32 s61, s31, 8
    s_add_u32 s60, s60, s61
    s_lshl_b32 s61, s65, 10
    s_add_u32 s61, s61, s60
    v_lshlrev_b32 v4, 4, v60
    v_cmp_gt_u32 vcc, 2, v61
    v_mov_b32 v10, s28
    v_mov_b32 v11, s29
    s_cmp_lg_u32 s27, 0
    s_cbranch_scc1 L_op_final
    v_pk_add_f32 v[12:13], v[16:17], v[18:19]
    v_pk_mul_f32 v[14:15], v[16:17], v[16:17]
    v_pk_fma_f32 v[14:15], v[18:19], v[18:19], v[14:15]
    v_pk_add_f32 v[12:13], v[12:13], v[20:21]
    v_pk_fma_f32 v[14:15], v[20:21], v[20:21], v[14:15]
    v_pk_add_f32 v[12:13], v[12:13], v[22:23]
    v_pk_fma_f32 v[14:15], v[22:23], v[22:23], v[14:15]
    v_pk_add_f32 v[12:13], v[12:13], v[24:25]
    v_pk_fma_f32 v[14:15], v[24:25], v[24:25], v[14:15]
    v_pk_add_f32 v[12:13], v[12:13], v[26:27]
    v_pk_fma_f32 v[14:15], v[26:27], v[26:27], v[14:15]
    v_pk_add_f32 v[12:13], v[12:13], v[28:29]
    v_pk_fma_f32 v[14:15], v[28:29], v[28:29], v[14:15]
    v_pk_add_f32 v[12:13], v[12:13], v[30:31]
    v_pk_fma_f32 v[14:15], v[30:31], v[30:31], v[14:15]
    v_cndmask_b32 v32, 0, v32, vcc
    v_cndmask_b32 v33, 0, v33, vcc
    v_cndmask_b32 v34, 0, v34, vcc
    v_cndmask_b32 v35, 0, v35, vcc
    v_pk_add_f32 v[12:13], v[12:13], v[32:33]
    v_pk_fma_f32 v[14:15], v[32:33], v[32:33], v[14:15]
    v_pk_add_f32 v[12:13], v[12:13], v[34:35]
    v_pk_fma_f32 v[14:15], v[34:35], v[34:35], v[14:15]
    v_add_f32 v8, v12, v13
    v_add_f32 v9, v14, v15
    v_mov_b32 v12, v8
    v_mov_b32 v13, v9
    s_nop 1
    v_permlane16_swap_b32 v8, v12
    v_permlane16_swap_b32 v9, v13
    s_nop 0
    v_add_f32 v8, v8, v12
    v_add_f32 v9, v9, v13
    v_mov_b32 v12, v8
    v_mov_b32 v13, v9
    s_nop 1
    v_permlane32_swap_b32 v8, v12
    v_permlane32_swap_b32 v9, v13
    s_nop 0
    v_add_f32 v8, v8, v12
    v_add_f32 v9, v9, v13
    s_mov_b64 exec, 0xffff
    buffer_store_dwordx4 v[8:11], v4, s[4:7], s61 offen sc1
    s_mov_b64 exec, -1
    v_lshl_add_u32 v4, v61, 10, v4
    s_add_u32 s61, s60, 4096
    s_waitcnt vmcnt(0)
    s_mov_b32 s96, 400000
Lq_80:
    buffer_load_dwordx4 v[136:139], v4, s[4:7], s60 offen offset:0 sc1
    buffer_load_dwordx4 v[140:143], v4, s[4:7], s61 offen offset:0 sc1
    s_waitcnt vmcnt(0)
    v_cmp_ne_u64 vcc, s[28:29], v[138:139]
    v_cmp_ne_u64 s[94:95], s[28:29], v[142:143]
    s_nop 0
    s_or_b64 vcc, vcc, s[94:95]
    s_cmp_eq_u64 vcc, 0
    s_cbranch_scc1 Lq0_81
    s_sub_u32 s96, s96, 1
    s_cmp_lg_u32 s96, 0
    s_cbranch_scc1 Lq_80
    v_mov_b32 v136, 7
    v_mov_b32 v137, 0
    global_store_dword v137, v136, s[52:53]
    s_waitcnt vmcnt(0)
Lq0_81:
    v_add_f32 v8, v136, v140
    v_add_f32 v9, v137, v141
    v_mov_b32 v12, v8
    v_mov_b32 v13, v9
    s_nop 1
    v_permlane16_swap_b32 v8, v12
    v_permlane16_swap_b32 v9, v13
    s_nop 0
    v_add_f32 v8, v8, v12
    v_add_f32 v9, v9, v13
    v_mov_b32 v12, v8
    v_mov_b32 v13, v9
    s_nop 1
    v_permlane32_swap_b32 v8, v12
    v_permlane32_swap_b32 v9, v13
    s_nop 0
    v_add_f32 v8, v8, v12
    v_add_f32 v9, v9, v13
    v_mul_f32 v8, 0x3ae38e39, v8
    v_mul_f32 v9, 0x3ae38e39, v9
    v_fma_f32 v10, -v8, v8, v9
    v_max_f32 v10, 0, v10
    v_add_f32 v10, 0x3727c5ac, v10
    v_rsq_f32 v12, v10
    s_nop 0
    v_mul_f32 v14, v8, v12
    v_sub_f32 v14, 0, v14
    v_mov_b32 v13, v12
    v_mov_b32 v15, v14
    s_add_u32 s60, s67, 14680064
    v_pk_fma_f32 v[96:97], v[16:17], v[12:13], v[14:15]
    v_pk_fma_f32 v[16:17], v[96:97], v[116:117], v[16:17]
    v_pk_fma_f32 v[98:99], v[18:19], v[12:13], v[14:15]
    v_pk_fma_f32 v[18:19], v[98:99], v[118:119], v[18:19]
    v_cvt_pk_bf16_f32 v76, v16, v17
    v_cvt_pk_bf16_f32 v77, v18, v19
    buffer_store_dwordx2 v[76:77], v63, s[4:7], s60 offen offset:0 sc1
    v_pk_fma_f32 v[100:101], v[20:21], v[12:13], v[14:15]
    v_pk_fma_f32 v[20:21], v[100:101], v[120:121], v[20:21]
    v_pk_fma_f32 v[102:103], v[22:23], v[12:13], v[14:15]
    v_pk_fma_f32 v[22:23], v[102:103], v[122:123], v[22:23]
    v_cvt_pk_bf16_f32 v78, v20, v21
    v_cvt_pk_bf16_f32 v79, v22, v23
    buffer_store_dwordx2 v[78:79], v63, s[4:7], s60 offen offset:256 sc1
    v_pk_fma_f32 v[104:105], v[24:25], v[12:13], v[14:15]
    v_pk_fma_f32 v[24:25], v[104:105], v[124:125], v[24:25]
    v_pk_fma_f32 v[106:107], v[26:27], v[12:13], v[14:15]
    v_pk_fma_f32 v[26:27], v[106:107], v[126:127], v[26:27]
    v_cvt_pk_bf16_f32 v80, v24, v25
    v_cvt_pk_bf16_f32 v81, v26, v27
    buffer_store_dwordx2 v[80:81], v63, s[4:7], s60 offen offset:2048 sc1
    v_pk_fma_f32 v[108:109], v[28:29], v[12:13], v[14:15]
    v_pk_fma_f32 v[28:29], v[108:109], v[240:241], v[28:29]
    v_pk_fma_f32 v[110:111], v[30:31], v[12:13], v[14:15]
    v_pk_fma_f32 v[30:31], v[110:111], v[242:243], v[30:31]
    v_cvt_pk_bf16_f32 v82, v28, v29
    v_cvt_pk_bf16_f32 v83, v30, v31
    buffer_store_dwordx2 v[82:83], v63, s[4:7], s60 offen offset:2304 sc1
    v_pk_fma_f32 v[112:113], v[32:33], v[12:13], v[14:15]
    v_pk_fma_f32 v[32:33], v[112:113], v[244:245], v[32:33]
    v_pk_fma_f32 v[114:115], v[34:35], v[12:13], v[14:15]
    v_pk_fma_f32 v[34:35], v[114:115], v[246:247], v[34:35]
    v_cvt_pk_bf16_f32 v84, v32, v33
    v_cvt_pk_bf16_f32 v85, v34, v35
    buffer_store_dwordx2 v[84:85], v64, s[4:7], s60 offen offset:0 sc1
    s_mov_b32 s27, 1
    s_mov_b32 s68, 14680064
    s_mov_b32 s87, 0
    v_lshlrev_b32 v4, 4, v2
    v_add_u32 v4, 99328, v4
    v_and_b32 v6, 31, v2
    v_cmp_gt_u32 vcc, 24, v6
    v_lshrrev_b32 v7, 5, v2
    s_nop 0
    v_cndmask_b32 v5, 23, v6, vcc
    v_lshlrev_b32 v5, 4, v5
    v_mul_u32_u24 v53, 384, v7
    v_add_u32 v5, v5, v53
    v_add_u32 v5, 100352, v5
    v_and_b32 v53, 15, v2
    v_lshlrev_b32 v53, 1, v53
    v_bfe_u32 v54, v2, 4, 1
    v_add_u32 v53, v53, v54
    v_lshlrev_b32 v53, 4, v53
    v_and_b32 v58, 19, v6
    v_bfe_u32 v54, v6, 2, 1
    v_lshl_add_u32 v58, v54, 3, v58
    v_bfe_u32 v54, v6, 3, 1
    v_lshl_add_u32 v58, v54, 2, v58
    v_lshlrev_b32 v54, 4, v58
    v_lshl_add_u32 v54, v7, 9, v54
    s_lshl_b32 s61, s30, 10
    v_add_u32 v54, s61, v54
    v_min_u32 v56, 19, v6
    v_cmp_eq_u32 vcc, 4, v56
    v_cmp_eq_u32 s[62:63], 19, v56
    s_mul_i32 s61, s30, 1280
    s_add_u32 s61, s61, 8192
    v_cndmask_b32 v56, v56, 19, vcc
    v_cndmask_b32 v56, v56, 4, s[62:63]
    v_lshlrev_b32 v56, 4, v56
    v_mul_u32_u24 v55, 320, v7
    v_add_u32 v56, v56, v55
    v_add_u32 v55, s61, v56
    s_lshl_b32 s62, s30, 7
    s_add_u32 s63, s62, 98304
    s_add_u32 s62, s62, 18432
    v_mov_b32 v59, s62
    v_mov_b32 v60, s63
    v_cmp_gt_u32 vcc, 22, v6
    v_and_b32 v57, 1, v6
    v_lshlrev_b32 v57, 1, v57
    v_lshl_add_u32 v57, v7, 5, v57
    v_cndmask_b32 v61, v59, v60, vcc
    v_add_u32 v57, v57, v61
    v_lshl_add_u32 v58, v58, 2, v60
    v_lshl_add_u32 v59, v6, 2, v59
    s_lshl_b32 s60, s26, 8
    s_add_u32 s60, s60, 96256
    v_lshl_add_u32 v60, v6, 2, s60
    v_mov_b32 v61, s60
    v_and_b32 v62, 30, v6
    v_cmp_eq_u32 vcc, 20, v62
    v_add_u32 v62, 128, v61
    s_nop 0
    v_cndmask_b32 v61, v61, v62, vcc
    v_cmp_eq_u32 vcc, 18, v6
    v_lshl_add_u32 v61, v7, 4, v61
    v_mov_b32 v62, 0x3f803f80
    v_cndmask_b32 v62, 0, v62, vcc
    s_lshl_b32 s69, s27, 5
    s_add_u32 s69, s69, s25
    s_lshl_b32 s69, s69, 3
    s_add_u32 s89, s69, s24
    s_mul_i32 s89, s89, 19456
    s_add_u32 s89, s89, 17825792
    s_lshl_b32 s60, s24, 11
    s_add_u32 s60, s60, 368640
    s_lshl_b32 s61, s25, 6
    s_add_u32 s61, s61, s60
    v_lshlrev_b32 v8, 6, v6
    v_mov_b32 v10, s28
    v_mov_b32 v11, s29
    v_mov_b32 v12, 0
    v_mov_b32 v13, 98304
    v_mov_b32 v14, 1
    s_add_u32 s62, s67, 14680064
    s_waitcnt vmcnt(0)
    s_mov_b64 exec, 1
    ds_add_rtn_u32 v14, v13, v14
    s_waitcnt lgkmcnt(0)
    v_readfirstlane_b32 s3, v14
    s_mov_b64 exec, -1
    s_cmp_lg_u32 s3, 3
    s_cbranch_scc1 L_84w
    s_mov_b64 exec, 1
    buffer_store_dwordx2 v[10:11], v12, s[4:7], s61 offen sc1
    s_mov_b64 exec, -1
L_84w:
    buffer_load_dwordx2 v[240:241], v63, s[4:7], s62 offen offset:0 sc1
    buffer_load_dwordx2 v[240:241], v63, s[4:7], s62 offen offset:256 sc1
    buffer_load_dwordx2 v[240:241], v63, s[4:7], s62 offen offset:2048 sc1
    buffer_load_dwordx2 v[240:241], v63, s[4:7], s62 offen offset:2304 sc1
    buffer_load_dwordx2 v[240:241], v64, s[4:7], s62 offen offset:0 sc1
    s_cbranch_scc1 L_84
    s_waitcnt vmcnt(0)
    s_mov_b32 s96, 400000
    s_mov_b64 exec, 1
Lp1_87:
    buffer_load_dwordx2 v[220:221], v8, s[4:7], s60 offen offset:0 sc1
    s_waitcnt vmcnt(0)
    v_cmp_eq_u64 vcc, s[28:29], v[220:221]
    s_nop 0
    s_cmp_lg_u64 vcc, 0
    s_cbranch_scc1 Lp1d_88
    s_sleep 2
    s_sub_u32 s96, s96, 1
    s_cmp_gt_u32 s96, 1
    s_cbranch_scc1 Lp1_87
Lp1d_88:
    s_mov_b64 exec, -1
Lpoll_85:
    buffer_load_dwordx2 v[220:221], v8, s[4:7], s60 offen offset:0 sc1
    s_waitcnt vmcnt(0)
    v_cmp_ne_u64 vcc, s[28:29], v[220:221]
    s_nop 0
    s_cmp_eq_u64 vcc, 0
    s_cbranch_scc1 Lpolld_86
    s_mov_b64 exec, vcc
    s_sleep 4
    s_sub_u32 s96, s96, 1
    s_cmp_lg_u32 s96, 0
    s_cbranch_scc1 Lpoll_85
    v_mov_b32 v220, 8
    v_mov_b32 v221, 0
    global_store_dword v221, v220, s[52:53]
    s_waitcnt vmcnt(0)
Lpolld_86:
    s_mov_b64 exec, -1
L_84:
    s_branch L_next_layer
L_op_help:
    s_sub_u32 s62, s26, 4
    s_mov_b32 s3, 0
    v_mov_b32 v4, 98304
    v_mov_b32 v5, 0
    ds_write_b32 v4, v5
    s_and_b32 s60, s25, 7
    s_mul_i32 s60, s60, 82944
    s_add_u32 s60, s60, 7396352
    s_add_u32 s61, s60, 26624
    s_mov_b32 m0, 56320
    s_lshl_b32 s62, s62, 10
    s_add_u32 s60, s60, s62
    s_add_u32 m0, m0, s62
    s_nop 0
L_89:
    buffer_load_dwordx4 v218, s[4:7], s60 offen sc1 lds
    s_add_u32 m0, m0, 4096
    s_add_u32 s60, s60, 4096
    s_cmp_lt_u32 s60, s61
    s_cbranch_scc1 L_89
    s_waitcnt vmcnt(0) lgkmcnt(0)
    s_barrier
    s_cmp_lg_u32 s27, 0
    s_cbranch_scc1 L_end
    s_mov_b32 s27, 1
    s_mov_b32 s68, 14680064
    s_mov_b32 s87, 0
    v_lshlrev_b32 v4, 4, v2
    v_add_u32 v4, 99328, v4
    v_and_b32 v6, 31, v2
    v_cmp_gt_u32 vcc, 24, v6
    v_lshrrev_b32 v7, 5, v2
    s_nop 0
    v_cndmask_b32 v5, 23, v6, vcc
    v_lshlrev_b32 v5, 4, v5
    v_mul_u32_u24 v53, 384, v7
    v_add_u32 v5, v5, v53
    v_add_u32 v5, 100352, v5
    v_and_b32 v53, 15, v2
    v_lshlrev_b32 v53, 1, v53
    v_bfe_u32 v54, v2, 4, 1
    v_add_u32 v53, v53, v54
    v_lshlrev_b32 v53, 4, v53
    v_and_b32 v58, 19, v6
    v_bfe_u32 v54, v6, 2, 1
    v_lshl_add_u32 v58, v54, 3, v58
    v_bfe_u32 v54, v6, 3, 1
    v_lshl_add_u32 v58, v54, 2, v58
    v_lshlrev_b32 v54, 4, v58
    v_lshl_add_u32 v54, v7, 9, v54
    s_lshl_b32 s61, s30, 10
    v_add_u32 v54, s61, v54
    v_min_u32 v56, 19, v6
    v_cmp_eq_u32 vcc, 4, v56
    v_cmp_eq_u32 s[62:63], 19, v56
    s_mul_i32 s61, s30, 1280
    s_add_u32 s61, s61, 8192
    v_cndmask_b32 v56, v56, 19, vcc
    v_cndmask_b32 v56, v56, 4, s[62:63]
    v_lshlrev_b32 v56, 4, v56
    v_mul_u32_u24 v55, 320, v7
    v_add_u32 v56, v56, v55
    v_add_u32 v55, s61, v56
    s_lshl_b32 s62, s30, 7
    s_add_u32 s63, s62, 98304
    s_add_u32 s62, s62, 18432
    v_mov_b32 v59, s62
    v_mov_b32 v60, s63
    v_cmp_gt_u32 vcc, 22, v6
    v_and_b32 v57, 1, v6
    v_lshlrev_b32 v57, 1, v57
    v_lshl_add_u32 v57, v7, 5, v57
    v_cndmask_b32 v61, v59, v60, vcc
    v_add_u32 v57, v57, v61
    v_lshl_add_u32 v58, v58, 2, v60
    v_lshl_add_u32 v59, v6, 2, v59
    s_lshl_b32 s60, s26, 8
    s_add_u32 s60, s60, 96256
    v_lshl_add_u32 v60, v6, 2, s60
    v_mov_b32 v61, s60
    v_and_b32 v62, 30, v6
    v_cmp_eq_u32 vcc, 20, v62
    v_add_u32 v62, 128, v61
    s_nop 0
    v_cndmask_b32 v61, v61, v62, vcc
    v_cmp_eq_u32 vcc, 18, v6
    v_lshl_add_u32 v61, v7, 4, v61
    v_mov_b32 v62, 0x3f803f80
    v_cndmask_b32 v62, 0, v62, vcc
    s_lshl_b32 s69, s27, 5
    s_add_u32 s69, s69, s25
    s_lshl_b32 s69, s69, 3
    s_add_u32 s89, s69, s24
    s_mul_i32 s89, s89, 19456
    s_add_u32 s89, s89, 17825792
L_next_layer:
    s_branch L_qkv
L_op_final:
    v_cvt_pk_bf16_f32 v76, v16, v17
    v_cvt_pk_bf16_f32 v77, v18, v19
    v_cvt_pk_bf16_f32 v78, v20, v21
    v_cvt_pk_bf16_f32 v79, v22, v23
    buffer_store_dwordx4 v[76:79], v72, s[8:11], s78 offen offset:0
    v_cvt_pk_bf16_f32 v80, v24, v25
    v_cvt_pk_bf16_f32 v81, v26, v27
    v_cvt_pk_bf16_f32 v82, v28, v29
    v_cvt_pk_bf16_f32 v83, v30, v31
    buffer_store_dwordx4 v[80:83], v72, s[8:11], s78 offen offset:64
    v_cvt_pk_bf16_f32 v84, v32, v33
    v_cvt_pk_bf16_f32 v85, v34, v35
    buffer_store_dwordx2 v[84:85], v73, s[8:11], s78 offen offset:128
    s_or_b32 s60, s2, s26
    s_cmp_lg_u32 s60, 0
    s_cbranch_scc1 L_end
    s_mov_b32 s60, 0
    v_mov_b32 v10, s28
    v_mov_b32 v11, s29
    v_mov_b32 v12, 0
    s_mov_b64 exec, 1
    buffer_store_dwordx2 v[10:11], v12, s[4:7], s60 offen sc1
    s_mov_b64 exec, -1
L_end:
    s_waitcnt vmcnt(0)
L_exit:
    s_endpgm
L_att_fallback:
    s_mov_b32 s72, 1
    s_mul_i32 s75, s69, 19456
    s_add_u32 s75, s75, 17825792
    v_mov_b32 v221, 0xff7fffff
    s_waitcnt vmcnt(0)
    s_mov_b32 s76, 0
Lfb_90:
    s_lshr_b32 s77, s76, 2
    s_and_b32 s78, s76, 3
    s_mul_i32 s77, s77, 19456
    s_add_u32 s77, s77, s75
    s_lshl_b32 s79, s78, 11
    s_add_u32 s79, s79, s77
    buffer_load_dwordx4 v[16:19], v218, s[4:7], s79 offen sc1
    buffer_load_dwordx4 v[20:23], v218, s[4:7], s79 offen offset:1024 sc1
    s_lshl_b32 s79, s78, 8
    s_add_u32 s79, s79, s77
    s_add_u32 s79, s79, 18432
    buffer_load_dword v24, v219, s[4:7], s79 offen sc1
    s_waitcnt vmcnt(0)
    v_mfma_f32_32x32x4bf16_1k v[128:159], v[24:25], v[212:213], 0
    s_nop 15
    s_nop 3
    v_mfma_f32_32x32x16_bf16 v[128:143], v[16:19], v[208:211], v[128:143]
    v_mfma_f32_32x32x16_bf16 v[144:159], v[20:23], v[208:211], v[144:159]
    s_nop 15
    v_max3_f32 v221, v221, v128, v129
    v_max3_f32 v221, v221, v130, v131
    v_max3_f32 v221, v221, v132, v133
    v_max3_f32 v221, v221, v134, v135
    v_max3_f32 v221, v221, v136, v137
    v_max3_f32 v221, v221, v138, v139
    v_max3_f32 v221, v221, v140, v141
    v_max3_f32 v221, v221, v142, v143
    v_max3_f32 v221, v221, v144, v145
    v_max3_f32 v221, v221, v146, v147
    v_max3_f32 v221, v221, v148, v149
    v_max3_f32 v221, v221, v150, v151
    v_max3_f32 v221, v221, v152, v153
    v_max3_f32 v221, v221, v154, v155
    v_max3_f32 v221, v221, v156, v157
    v_max3_f32 v221, v221, v158, v159
    s_add_u32 s76, s76, 1
    s_cmp_lt_u32 s76, 32
    s_cbranch_scc1 Lfb_90
    v_mov_b32 v227, v221
    s_nop 1
    v_permlane32_swap_b32 v221, v227
    s_nop 1
    v_max_f32 v221, v221, v227
    v_mov_b32 v192, 0
    v_mov_b32 v193, 0
    v_mov_b32 v194, 0
    v_mov_b32 v195, 0
    v_mov_b32 v196, 0
    v_mov_b32 v197, 0
    v_mov_b32 v198, 0
    v_mov_b32 v199, 0
    v_mov_b32 v200, 0
    v_mov_b32 v201, 0
    v_mov_b32 v202, 0
    v_mov_b32 v203, 0
    v_mov_b32 v204, 0
    v_mov_b32 v205, 0
    v_mov_b32 v206, 0
    v_mov_b32 v207, 0
    s_mov_b32 s76, 0
Lfb_91:
    s_lshr_b32 s77, s76, 2
    s_and_b32 s78, s76, 3
    s_mul_i32 s77, s77, 19456
    s_add_u32 s77, s77, s75
    s_lshl_b32 s79, s78, 11
    s_add_u32 s79, s79, s77
    buffer_load_dwordx4 v[16:19], v218, s[4:7], s79 offen sc1
    buffer_load_dwordx4 v[20:23], v218, s[4:7], s79 offen offset:1024 sc1
    s_lshl_b32 s79, s78, 8
    s_add_u32 s79, s79, s77
    s_add_u32 s79, s79, 18432
    buffer_load_dword v24, v219, s[4:7], s79 offen sc1
    s_mul_i32 s79, s78, 2560
    s_add_u32 s79, s79, s77
    s_add_u32 s79, s79, 8192
    buffer_load_dwordx4 v[28:31], v220, s[4:7], s79 offen offset:0 sc1
    buffer_load_dwordx4 v[32:35], v220, s[4:7], s79 offen offset:640 sc1
    buffer_load_dwordx4 v[36:39], v220, s[4:7], s79 offen offset:1280 sc1
    buffer_load_dwordx4 v[40:43], v220, s[4:7], s79 offen offset:1920 sc1
    s_waitcnt vmcnt(0)
    v_mfma_f32_32x32x4bf16_1k v[128:159], v[24:25], v[212:213], 0
    s_nop 15
    s_nop 3
    v_mfma_f32_32x32x16_bf16 v[128:143], v[16:19], v[208:211], v[128:143]
    v_mfma_f32_32x32x16_bf16 v[144:159], v[20:23], v[208:211], v[144:159]
    s_nop 15
    v_sub_f32 v128, v128, v221
    v_sub_f32 v129, v129, v221
    v_sub_f32 v130, v130, v221
    v_sub_f32 v131, v131, v221
    v_sub_f32 v132, v132, v221
    v_sub_f32 v133, v133, v221
    v_sub_f32 v134, v134, v221
    v_sub_f32 v135, v135, v221
    v_sub_f32 v136, v136, v221
    v_sub_f32 v137, v137, v221
    v_sub_f32 v138, v138, v221
    v_sub_f32 v139, v139, v221
    v_sub_f32 v140, v140, v221
    v_sub_f32 v141, v141, v221
    v_sub_f32 v142, v142, v221
    v_sub_f32 v143, v143, v221
    v_sub_f32 v144, v144, v221
    v_sub_f32 v145, v145, v221
    v_sub_f32 v146, v146, v221
    v_sub_f32 v147, v147, v221
    v_sub_f32 v148, v148, v221
    v_sub_f32 v149, v149, v221
    v_sub_f32 v150, v150, v221
    v_sub_f32 v151, v151, v221
    v_sub_f32 v152, v152, v221
    v_sub_f32 v153, v153, v221
    v_sub_f32 v154, v154, v221
    v_sub_f32 v155, v155, v221
    v_sub_f32 v156, v156, v221
    v_sub_f32 v157, v157, v221
    v_sub_f32 v158, v158, v221
    v_sub_f32 v159, v159, v221
    v_exp_f32 v128, v128
    v_exp_f32 v129, v129
    v_exp_f32 v130, v130
    v_exp_f32 v131, v131
    v_exp_f32 v132, v132
    v_exp_f32 v133, v133
    v_exp_f32 v134, v134
    v_exp_f32 v135, v135
    v_exp_f32 v136, v136
    v_exp_f32 v137, v137
    v_exp_f32 v138, v138
    v_exp_f32 v139, v139
    v_exp_f32 v140, v140
    v_exp_f32 v141, v141
    v_exp_f32 v142, v142
    v_exp_f32 v143, v143
    v_exp_f32 v144, v144
    v_exp_f32 v145, v145
    v_exp_f32 v146, v146
    v_exp_f32 v147, v147
    v_exp_f32 v148, v148
    v_exp_f32 v149, v149
    v_exp_f32 v150, v150
    v_exp_f32 v151, v151
    v_exp_f32 v152, v152
    v_exp_f32 v153, v153
    v_exp_f32 v154, v154
    v_exp_f32 v155, v155
    v_exp_f32 v156, v156
    v_exp_f32 v157, v157
    v_exp_f32 v158, v158
    v_exp_f32 v159, v159
    s_nop 1
    v_smfmac_f32_32x32x32_bf16 v[192:207], v[28:31], v[128:135], v214
    v_smfmac_f32_32x32x32_bf16 v[192:207], v[32:35], v[136:143], v214
    v_smfmac_f32_32x32x32_bf16 v[192:207], v[36:39], v[144:151], v214
    v_smfmac_f32_32x32x32_bf16 v[192:207], v[40:43], v[152:159], v214
    s_add_u32 s76, s76, 1
    s_cmp_lt_u32 s76, 32
    s_cbranch_scc1 Lfb_91
    s_nop 15
    s_branch L_att_norm
L_try:
    s_waitcnt vmcnt(0)
    v_cmp_eq_u64 vcc, s[28:29], v[6:7]
L_92:
    s_lshl_b32 s60, s62, 3
    s_lshr_b32 s60, vcc_lo, s60
    s_and_b32 s60, s60, 0xff
    s_cmp_lg_u32 s60, 0xff
    s_cbranch_scc1 L_93
    s_add_u32 s60, s24, s62
    s_add_u32 s60, s60, 1
    s_and_b32 s60, s60, 7
    s_add_u32 s60, s60, s69
    s_mul_i32 s60, s60, 19456
    s_add_u32 s60, s60, 17825792
    s_mul_i32 s63, s62, 38912
    s_sub_u32 s63, 76544, s63
    s_add_u32 m0, s63, 0
    s_add_u32 s86, s60, 0
    buffer_load_dwordx4 v218, s[4:7], s86 offen sc1 lds
    s_add_u32 m0, s63, 1024
    s_add_u32 s86, s60, 1024
    buffer_load_dwordx4 v218, s[4:7], s86 offen sc1 lds
    s_add_u32 m0, s63, 2048
    s_add_u32 s86, s60, 2048
    buffer_load_dwordx4 v218, s[4:7], s86 offen sc1 lds
    s_add_u32 m0, s63, 3072
    s_add_u32 s86, s60, 3072
    buffer_load_dwordx4 v218, s[4:7], s86 offen sc1 lds
    s_add_u32 m0, s63, 4096
    s_add_u32 s86, s60, 4096
    buffer_load_dwordx4 v218, s[4:7], s86 offen sc1 lds
    s_add_u32 m0, s63, 5120
    s_add_u32 s86, s60, 5120
    buffer_load_dwordx4 v218, s[4:7], s86 offen sc1 lds
    s_add_u32 m0, s63, 6144
    s_add_u32 s86, s60, 6144
    buffer_load_dwordx4 v218, s[4:7], s86 offen sc1 lds
    s_add_u32 m0, s63, 7168
    s_add_u32 s86, s60, 7168
    buffer_load_dwordx4 v218, s[4:7], s86 offen sc1 lds
    s_add_u32 m0, s63, 8192
    s_add_u32 s86, s60, 8192
    buffer_load_dwordx4 v218, s[4:7], s86 offen sc1 lds
    s_add_u32 m0, s63, 9216
    s_add_u32 s86, s60, 9216
    buffer_load_dwordx4 v218, s[4:7], s86 offen sc1 lds
    s_add_u32 m0, s63, 10240
    s_add_u32 s86, s60, 10240
    buffer_load_dwordx4 v218, s[4:7], s86 offen sc1 lds
    s_add_u32 m0, s63, 11264
    s_add_u32 s86, s60, 11264
    buffer_load_dwordx4 v218, s[4:7], s86 offen sc1 lds
    s_add_u32 m0, s63, 12288
    s_add_u32 s86, s60, 12288
    buffer_load_dwordx4 v218, s[4:7], s86 offen sc1 lds
    s_add_u32 m0, s63, 13312
    s_add_u32 s86, s60, 13312
    buffer_load_dwordx4 v218, s[4:7], s86 offen sc1 lds
    s_add_u32 m0, s63, 14336
    s_add_u32 s86, s60, 14336
    buffer_load_dwordx4 v218, s[4:7], s86 offen sc1 lds
    s_add_u32 m0, s63, 15360
    s_add_u32 s86, s60, 15360
    buffer_load_dwordx4 v218, s[4:7], s86 offen sc1 lds
    s_add_u32 m0, s63, 16384
    s_add_u32 s86, s60, 16384
    buffer_load_dwordx4 v218, s[4:7], s86 offen sc1 lds
    s_add_u32 m0, s63, 17408
    s_add_u32 s86, s60, 17408
    buffer_load_dwordx4 v218, s[4:7], s86 offen sc1 lds
    s_add_u32 m0, s63, 18432
    s_add_u32 s86, s60, 18432
    buffer_load_dwordx4 v218, s[4:7], s86 offen sc1 lds
    s_add_u32 s62, s62, 1
    s_cmp_lt_u32 s62, 2
    s_cbranch_scc1 L_92
    s_setpc_b64 s[76:77]
L_93:
    s_mov_b64 exec, 0xffff
    buffer_load_dwordx2 v[6:7], v4, s[4:7], s61 offen sc1
    s_mov_b64 exec, -1
    s_setpc_b64 s[76:77]
L_code_end:
.section .rodata,"a"
.p2align 6
.amdhsa_kernel interleave_layers__ssm_conv_h3__softmax_full_mha__prompt_kernel
  .amdhsa_next_free_vgpr 256
  .amdhsa_next_free_sgpr 102
  .amdhsa_accum_offset 256
  .amdhsa_group_segment_fixed_size 0
  .amdhsa_kernarg_size 96
  .amdhsa_user_sgpr_count 2
  .amdhsa_user_sgpr_kernarg_segment_ptr 1
  .amdhsa_system_sgpr_workgroup_id_x 1
.end_amdhsa_kernel
```
